```python
import torch

def _softmax(x, axis=-1):
    return torch.softmax(x, dim=axis)
def _gelu(x):
    return torch.nn.functional.gelu(x, approximate="tanh")
def _silu(x):
    return torch.nn.functional.silu(x)
def _sigmoid(x):
    return torch.sigmoid(x)
def _layernorm(x, axis=-1, eps=1e-5):
    m = x.mean(dim=axis, keepdim=True)
    v = x.var(dim=axis, keepdim=True, unbiased=False)
    return (x - m) / torch.sqrt(v + eps)
def _scatter_add(tgt, idx, src, axis=0):
    return tgt.clone().index_add_(axis, idx, src)
def _segment_sum(src, seg, n):
    out = torch.zeros((n,) + src.shape[1:], dtype=src.dtype)
    return out.index_add_(0, seg, src)
def _pad(x, pw):
    flat = tuple(v for pair in reversed(pw) for v in pair)
    return torch.nn.functional.pad(x, flat)

kernel_name = 'interleave_layers__ssm_conv_s4d__spectral_gfnet__prompt'

def setup_inputs():

    _w = (lambda a: (lambda t: t.to(torch.bfloat16) if t.is_floating_point() else t)(torch.as_tensor(a)))
    def _A_setup():
        Bsz, L, D, N = 1, 2048, 512, 128
        return {
            "u": _w((lambda *s: torch.randn(*s, dtype=torch.bfloat16) * 0.05)(Bsz, L, D)),
            "log_A_real": _w((lambda *s: torch.randn(*s, dtype=torch.bfloat16) * 3.2)(D, N) * 0.5),
            "A_imag": _w((lambda *s: torch.randn(*s, dtype=torch.bfloat16) * 0.05)(D, N) * 3.14),
            "C_real": _w((lambda *s: torch.randn(*s, dtype=torch.bfloat16) * 0.05)(D, N) / N ** 0.5),
            "C_imag": _w((lambda *s: torch.randn(*s, dtype=torch.bfloat16) * 0.05)(D, N) / N ** 0.5),
            "log_dt": _w((lambda *s: torch.randn(*s, dtype=torch.bfloat16) * 0.05)(D) * 0.5 - 4.0),
            "D_skip": _w((lambda *s: torch.randn(*s, dtype=torch.bfloat16) * 0.05)(D)),
        }
    _A_in = _A_setup()

    def _B_setup():
        B, S, D = 1, 2048, 512
        Df = D // 2 + 1
        return {
            "x": _w((lambda *s: torch.randn(*s, dtype=torch.bfloat16) * 0.05)(B, S, D)),
            "w_r": _w((lambda *s: torch.randn(*s, dtype=torch.bfloat16) * 3.2)(S, Df) * 0.02),
            "w_i": _w((lambda *s: torch.randn(*s, dtype=torch.bfloat16) * 3.2)(S, Df) * 0.02),
        }
    _B_in = _B_setup()

    return {
        "A_u": _A_in["u"],
        "A_log_A_real": _A_in["log_A_real"],
        "A_A_imag": _A_in["A_imag"],
        "A_C_real": _A_in["C_real"],
        "A_C_imag": _A_in["C_imag"],
        "A_log_dt": _A_in["log_dt"],
        "A_D_skip": _A_in["D_skip"],
        "B_x": _B_in["x"],
        "B_w_r": _B_in["w_r"],
        "B_w_i": _B_in["w_i"],
    }

def reference(A_u, A_log_A_real, A_A_imag, A_C_real, A_C_imag, A_log_dt, A_D_skip, B_x, B_w_r, B_w_i):
    def _A_ref(u, log_A_real, A_imag, C_real, C_imag, log_dt, D_skip):
        L = u.shape[1]
        dt = torch.exp(log_dt)
        A = -torch.exp(log_A_real) + 1j * A_imag
        C = (C_real + 1j * C_imag) * dt[:, None]
        pos = (lambda x, dt: x.to(dt))(torch.arange(L), log_dt.dtype)
        P = torch.exp((A * dt[:, None])[:, :, None] * pos[None, None, :])
        K = 2.0 * torch.einsum("dn,dnl->dl", C, P).real
        L2 = 2 * L
        u_t = (lambda x, *d: x.permute(*d))(u, 0, 2, 1)
        Kf = (lambda x, *a, **k: torch.fft.rfft(x.float(), *a, **k))(K, L2)
        Uf = (lambda x, *a, **k: torch.fft.rfft(x.float(), *a, **k))(u_t, L2)
        y = (lambda x, *a, **k: torch.fft.irfft(x, *a, **k).to(torch.bfloat16))(Uf * Kf[None, :, :], L2)[:, :, :L]
        y = (lambda x, *d: x.permute(*d))(y, 0, 2, 1)
        return y + u * D_skip[None, None, :]

    def _B_ref(x, w_r, w_i):
        B, S, D = x.shape
        X = (lambda x, axes=(-2,-1): torch.fft.rfft2(x.float(), dim=axes))(x, axes=(-2, -1))
        W = w_r + 1j * w_i
        X = X * W
        y = (lambda x, s, axes=(-2,-1): torch.fft.irfft2(x, s=s, dim=axes).to(torch.bfloat16))(X, (S, D), axes=(-2, -1))
        return y

    x = A_u
    x = x + _A_ref(_layernorm(x, axis=-1), A_log_A_real, A_A_imag, A_C_real, A_C_imag, A_log_dt, A_D_skip)
    x = x + _B_ref(_layernorm(x, axis=-1), B_w_r, B_w_i)
    x = x + _A_ref(_layernorm(x, axis=-1), A_log_A_real, A_A_imag, A_C_real, A_C_imag, A_log_dt, A_D_skip)
    x = x + _B_ref(_layernorm(x, axis=-1), B_w_r, B_w_i)
    return x
```

```asm
; @launch grid=(256,1,1) block=(512,1,1) lds=159456
.amdgcn_target "amdgcn-amd-amdhsa--gfx950"
.text
.globl interleave_layers__ssm_conv_s4d__spectral_gfnet__prompt_kernel
.p2align 8
.type interleave_layers__ssm_conv_s4d__spectral_gfnet__prompt_kernel,@function
interleave_layers__ssm_conv_s4d__spectral_gfnet__prompt_kernel:
    s_cmp_ge_u32 s2, 256
    s_cbranch_scc1 L_end
    s_load_dwordx2 s[20:21], s[0:1], 0
    s_load_dwordx2 s[8:9], s[0:1], 96
    s_load_dwordx2 s[24:25], s[0:1], 8
    s_load_dwordx2 s[28:29], s[0:1], 16
    s_load_dwordx2 s[32:33], s[0:1], 24
    s_load_dwordx2 s[36:37], s[0:1], 32
    s_load_dwordx2 s[40:41], s[0:1], 40
    s_load_dwordx2 s[44:45], s[0:1], 48
    s_load_dwordx2 s[48:49], s[0:1], 64
    s_load_dwordx2 s[52:53], s[0:1], 72
    s_load_dwordx2 s[16:17], s[0:1], 88
    s_load_dwordx2 s[12:13], s[0:1], 80
    s_getpc_b64 s[56:57]
L_pc:
    v_lshrrev_b32 v1, 6, v0
    s_mov_b32 s58, L_table_end-L_pc
    s_mov_b32 s59, 0x20000
    v_readfirstlane_b32 s4, v1
    v_and_b32 v1, 63, v0
    s_lshr_b32 s5, s2, 3
    v_lshlrev_b32 v72, 4, v1
    s_lshl_b32 s82, s4, 5
    s_add_u32 s82, s82, s5
    s_lshl_b32 s82, s82, 10
    buffer_load_dwordx4 v[76:79], v72, s[56:59], s82 offen
    s_lshl_b32 s82, s4, 10
    s_add_u32 m0, s82, 130784
    s_add_u32 s82, s82, L_table-L_pc
    buffer_load_dwordx4 v72, s[56:59], s82 offen lds
    s_add_u32 m0, m0, 8192
    s_add_u32 s82, s82, 8192
    buffer_load_dwordx4 v72, s[56:59], s82 offen lds
    s_add_u32 m0, m0, 8192
    s_add_u32 s82, s82, 8192
    buffer_load_dwordx4 v72, s[56:59], s82 offen lds
    s_cmp_ge_u32 s4, 4
    s_cbranch_scc1 L_dma_1
    s_add_u32 m0, m0, 8192
    s_add_u32 s82, s82, 8192
    buffer_load_dwordx4 v72, s[56:59], s82 offen lds
L_dma_1:
    s_and_b32 s3, s2, 7
    s_lshl_b32 s3, s3, 5
    s_add_u32 s3, s3, s5
    v_and_b32 v2, 15, v0
    v_lshrrev_b32 v3, 4, v1
    s_mul_i32 s6, s3, 8320
    v_lshl_add_u32 v4, v0, 4, s6
    v_lshlrev_b32 v21, 7, v3
    v_lshl_add_u32 v21, v2, 1, v21
    s_mov_b32 s60, 2129920
    s_mov_b32 s71, 0
    s_mov_b32 s22, 2097152
    s_mov_b32 s23, 0x20000
    s_mov_b32 s10, 4259840
    s_mov_b32 s11, 0x20000
    s_mov_b32 s26, 131072
    s_mov_b32 s27, 0x20000
    s_mov_b32 s30, 131072
    s_mov_b32 s31, 0x20000
    s_mov_b32 s34, 131072
    s_mov_b32 s35, 0x20000
    s_mov_b32 s38, 131072
    s_mov_b32 s39, 0x20000
    s_mov_b32 s42, 1024
    s_mov_b32 s43, 0x20000
    s_mov_b32 s46, 1024
    s_mov_b32 s47, 0x20000
    s_mov_b32 s50, 1052672
    s_mov_b32 s51, 0x20000
    s_mov_b32 s54, 1052672
    s_mov_b32 s55, 0x20000
    s_mov_b32 s18, 256
    s_mov_b32 s19, 0x20000
    s_mov_b32 s14, 2097152
    s_mov_b32 s15, 0x20000
    s_lshl_b32 s68, s3, 3
    s_add_u32 s68, s68, s4
    s_lshl_b32 s68, s68, 10
    s_bfe_u32 s84, s4, 0x10001
    s_lshl_b32 s82, s3, 1
    s_add_u32 s82, s82, s84
    s_and_b32 s83, s82, 4
    s_lshl_b32 s70, s83, 6
    s_and_b32 s83, s82, 3
    s_lshl_b32 s83, s83, 4
    s_add_u32 s70, s70, s83
    s_bfe_u32 s83, s82, 0x40003
    s_add_u32 s70, s70, s83
    s_lshr_b32 s82, s82, 7
    s_lshl_b32 s82, s82, 6
    s_add_u32 s70, s70, s82
    s_lshl_b32 s69, s70, 8
    s_lshl_b32 s70, s70, 1
    s_and_b32 s82, s4, 1
    s_lshl_b32 s82, s82, 7
    s_add_u32 s69, s69, s82
    v_mov_b32 v64, 0
    v_mov_b32 v65, 0
    v_mov_b32 v66, 0
    v_mov_b32 v67, 0
    v_lshlrev_b32 v70, 1, v1
    v_mov_b32 v71, 0
    v_lshrrev_b32 v73, 1, v0
    v_and_b32 v74, 1, v0
    s_lshl_b32 s82, s3, 5
    v_mul_u32_u24 v84, 8320, v73
    v_lshl_add_u32 v5, v74, 4, v84
    v_add_u32 v5, s82, v5
    v_lshlrev_b32 v11, 1, v0
    v_add_u32 v11, 87904, v11
    s_mul_i32 s83, s4, 1040
    s_add_u32 s83, s83, 87904
    v_lshl_add_u32 v12, v1, 4, s83
    v_lshrrev_b32 v14, 2, v73
    v_mul_u32_u24 v14, 96, v14
    v_and_b32 v75, 3, v73
    v_lshl_add_u32 v14, v75, 4, v14
    v_mul_u32_u24 v75, 7584, v74
    v_add_u32 v14, v14, v75
    v_add_u32 v14, 74176, v14
    v_lshrrev_b32 v84, 1, v3
    v_and_b32 v85, 1, v3
    v_lshrrev_b32 v86, 3, v2
    v_and_b32 v87, 7, v2
    s_lshl_b32 s83, s84, 6
    s_add_u32 s83, s83, s6
    v_lshl_add_u32 v8, v85, 1, v84
    v_lshlrev_b32 v8, 4, v8
    v_lshl_add_u32 v8, v2, 7, v8
    v_add_u32 v8, s83, v8
    s_mul_i32 s83, s84, 18944
    s_add_u32 s83, s83, 21968
    v_sub_u32 v15, v3, v86
    v_lshlrev_b32 v15, 4, v15
    v_mul_u32_u24 v16, 2368, v87
    v_sub_u32 v15, v15, v16
    v_add_u32 v15, s83, v15
    s_lshl_b32 s83, s84, 12
    s_add_u32 s83, s83, 87904
    v_lshl_add_u32 v23, v1, 4, s83
    s_mul_i32 s83, s84, 7584
    s_add_u32 s83, s83, 72736
    v_mul_u32_u24 v16, 96, v2
    v_lshl_add_u32 v16, v3, 4, v16
    v_add_u32 v16, s83, v16
    s_mov_b32 s81, 0x3fb8aa3b
    s_waitcnt lgkmcnt(0)
    buffer_load_short_d16_hi v24, v21, s[20:23], s68 offen offset:0
    buffer_load_short_d16_hi v25, v21, s[20:23], s68 offen offset:32
    buffer_load_short_d16_hi v26, v21, s[20:23], s68 offen offset:64
    buffer_load_short_d16_hi v27, v21, s[20:23], s68 offen offset:96
    buffer_load_short_d16_hi v28, v21, s[20:23], s68 offen offset:512
    buffer_load_short_d16_hi v29, v21, s[20:23], s68 offen offset:544
    buffer_load_short_d16_hi v30, v21, s[20:23], s68 offen offset:576
    buffer_load_short_d16_hi v31, v21, s[20:23], s68 offen offset:608
    buffer_load_short_d16_hi v144, v70, s[24:27], s69 offen
    buffer_load_short_d16_hi v145, v70, s[28:31], s69 offen
    buffer_load_short_d16_hi v146, v70, s[32:35], s69 offen
    buffer_load_short_d16_hi v147, v70, s[36:39], s69 offen
    buffer_load_short_d16_hi v148, v71, s[40:43], s70 offen
    s_bfe_u32 s82, s3, 0x30002
    s_and_b32 s83, s3, 3
    s_lshl_b32 s83, s83, 3
    s_add_u32 s82, s82, s83
    s_lshr_b32 s83, s3, 6
    s_lshl_b32 s83, s83, 5
    s_add_u32 s82, s82, s83
    s_bfe_u32 s83, s3, 0x10005
    s_lshl_b32 s83, s83, 10
    s_add_u32 s82, s82, s83
    s_lshr_b32 s83, s4, 2
    s_lshl_b32 s83, s83, 9
    s_add_u32 s82, s82, s83
    s_mul_i32 s72, s82, 514
    s_add_u32 s73, s72, 65792
    s_add_u32 s74, s72, 131584
    s_add_u32 s75, s72, 197376
    v_and_b32 v131, 0xff, v0
    v_lshlrev_b32 v134, 1, v131
    v_add_u32 v134, 2, v134
    s_cmp_ge_u32 s4, 3
    s_cbranch_scc1 L_zp_2
    v_mul_u32_u24 v85, 7584, v74
    v_lshl_add_u32 v85, v73, 4, v85
    v_add_u32 v85, 72736, v85
    ds_write_b128 v85, v[64:67]
    v_mul_u32_u24 v85, 2688, v74
    ds_write_b32 v85, v64 offset:2624
    ds_write_b32 v85, v64 offset:2640
    ds_write_b64 v23, v[64:65] offset:37760
    v_bfe_u32 v85, v1, 4, 1
    v_mul_u32_u24 v85, 784, v85
    v_bfe_u32 v86, v1, 3, 1
    v_mul_u32_u24 v86, 384, v86
    v_and_b32 v87, 7, v1
    v_lshlrev_b32 v87, 4, v87
    v_add3_u32 v85, v85, v86, v87
    v_add_u32 v85, 71168, v85
    ds_write_b128 v85, v[64:67]
L_zp_2:
    buffer_store_dwordx4 v[64:67], v4, s[8:11], 0 offen sc1
    s_waitcnt vmcnt(14) lgkmcnt(0)
    s_barrier
    buffer_store_dwordx4 v[64:67], v4, s[8:11], s60 offen sc1
    v_lshlrev_b32 v84, 2, v131
    v_add_u32 v84, 153376, v84
    ds_read_b32 v149, v84
    s_and_b32 s83, s4, 3
    s_lshl_b32 s84, s83, 10
    s_add_u32 s84, s84, 154400
    v_lshl_add_u32 v84, v1, 4, s84
    ds_read_b128 v[112:115], v84
    v_lshlrev_b32 v84, 4, v1
    v_add_u32 v84, 157472, v84
    ds_read_b128 v[56:59], v84
    s_cmp_ge_u32 s4, 4
    s_cbranch_scc1 L_e1_3
    s_and_b32 s82, s4, 1
    s_lshl_b32 s82, s82, 6
    s_add_u32 s82, s82, 8
    v_add_u32 v131, s82, v1
    s_lshr_b32 s82, s4, 1
    v_mov_b32 v87, s82
    s_branch L_e2_4
L_e1_3:
    v_and_b32 v131, 1, v1
    v_add_u32 v131, 6, v131
    v_bfe_u32 v87, v1, 1, 1
L_e2_4:
    v_lshlrev_b32 v131, 4, v131
    v_add_u32 v86, 151168, v131
    ds_read_b128 v[136:139], v86
    ds_read_b128 v[140:143], v86 offset:16
    v_mul_u32_u24 v86, 18944, v87
    v_add_u32 v131, v131, v86
    v_add_u32 v131, 5376, v131
    v_mul_u32_u24 v87, 2688, v87
    s_lshr_b32 s82, s4, 2
    s_mul_i32 s84, s82, 31008
    s_add_u32 s84, s84, 5376
    v_mul_u32_u24 v132, 544, v2
    v_lshl_add_u32 v132, v3, 4, v132
    v_add_u32 v132, s84, v132
    s_mul_i32 s85, s83, 8704
    s_add_u32 s85, s85, 8704
    v_add_u32 v133, s85, v132
    s_lshl_b32 s84, s82, 4
    s_add_u32 s84, s84, 104544
    s_mul_i32 s85, s82, 2688
    v_mov_b32 v95, s85
    s_mul_i32 s85, s82, 784
    v_mov_b32 v94, s85
    s_waitcnt lgkmcnt(0)
    v_add_u32 v149, s84, v149
    v_add_u32 v112, v112, v95
    v_add_u32 v56, v56, v94
    v_add_u32 v113, v113, v95
    v_add_u32 v57, v57, v94
    v_add_u32 v114, v114, v95
    v_add_u32 v58, v58, v94
    v_add_u32 v115, v115, v95
    v_add_u32 v59, v59, v94
    v_and_b32 v116, 0xffff, v136
    v_add_u32 v116, v116, v87
    v_lshrrev_b32 v117, 16, v136
    v_add_u32 v117, v117, v87
    v_and_b32 v118, 0xffff, v137
    v_add_u32 v118, v118, v87
    v_lshrrev_b32 v119, 16, v137
    v_add_u32 v119, v119, v87
    v_and_b32 v120, 0xffff, v138
    v_add_u32 v120, v120, v87
    v_lshrrev_b32 v121, 16, v138
    v_add_u32 v121, v121, v87
    v_and_b32 v122, 0xffff, v139
    v_add_u32 v122, v122, v87
    v_lshrrev_b32 v123, 16, v139
    v_add_u32 v123, v123, v87
    v_and_b32 v124, 0xffff, v140
    v_add_u32 v124, v124, v87
    v_lshrrev_b32 v125, 16, v140
    v_add_u32 v125, v125, v87
    v_and_b32 v126, 0xffff, v141
    v_add_u32 v126, v126, v87
    v_lshrrev_b32 v127, 16, v141
    v_add_u32 v127, v127, v87
    v_and_b32 v128, 0xffff, v142
    v_add_u32 v128, v128, v87
    v_lshrrev_b32 v129, 16, v142
    v_add_u32 v129, v129, v87
    v_and_b32 v130, 0xffff, v143
    v_add_u32 v130, v130, v87
    v_mov_b32 v136, 0
    v_mov_b32 v137, 0
    v_mov_b32 v138, 0
    v_mov_b32 v139, 0
    s_waitcnt vmcnt(7)
    buffer_load_short_d16 v32, v134, s[48:51], s72 offen
    buffer_load_short_d16_hi v36, v134, s[52:55], s72 offen
    buffer_load_short_d16 v33, v134, s[48:51], s73 offen
    buffer_load_short_d16_hi v37, v134, s[52:55], s73 offen
    buffer_load_short_d16 v34, v134, s[48:51], s74 offen
    buffer_load_short_d16_hi v38, v134, s[52:55], s74 offen
    buffer_load_short_d16 v35, v134, s[48:51], s75 offen
    buffer_load_short_d16_hi v39, v134, s[52:55], s75 offen
    v_pk_mul_f32 v[74:75], v[24:25], v[24:25]
    v_pk_add_f32 v[76:77], v[24:25], v[26:27]
    v_pk_fma_f32 v[74:75], v[26:27], v[26:27], v[74:75]
    v_pk_add_f32 v[72:73], v[28:29], v[30:31]
    v_pk_fma_f32 v[74:75], v[28:29], v[28:29], v[74:75]
    v_pk_add_f32 v[76:77], v[76:77], v[72:73]
    v_pk_fma_f32 v[74:75], v[30:31], v[30:31], v[74:75]
    v_add_f32 v72, v76, v77
    v_add_f32 v73, v74, v75
    s_nop 1
    v_permlane32_swap_b32 v72, v73
    v_add_f32 v72, v72, v73
    v_mov_b32 v73, v72
    s_nop 1
    v_permlane16_swap_b32 v72, v73
    v_add_f32 v72, v72, v73
    s_nop 1
    v_add_f32_dpp v72, v72, v72 quad_perm:[1,0,3,2] row_mask:0xf bank_mask:0xf
    s_nop 1
    v_add_f32_dpp v72, v72, v72 quad_perm:[2,3,0,1] row_mask:0xf bank_mask:0xf
    s_nop 1
    v_add_f32_dpp v72, v72, v72 row_half_mirror row_mask:0xf bank_mask:0xf
    s_nop 1
    v_add_f32_dpp v72, v72, v72 row_mirror row_mask:0xf bank_mask:0xf
    v_mul_f32 v72, 0x3b000000, v72
    v_mov_b32 v73, v72
    s_nop 1
    v_permlane32_swap_b32 v72, v73
    v_add_f32 v73, 0x3727c5ac, v73
    v_fma_f32 v73, -v72, v72, v73
    v_max_f32 v73, 0x3727c5ac, v73
    v_rsq_f32 v73, v73
    s_nop 0
    v_mul_f32 v72, v72, v73
    v_pk_fma_f32 v[48:49], v[24:25], v[72:73], v[72:73] op_sel:[0,1,0] op_sel_hi:[1,1,0] neg_lo:[0,0,1] neg_hi:[0,0,1]
    v_pk_fma_f32 v[50:51], v[26:27], v[72:73], v[72:73] op_sel:[0,1,0] op_sel_hi:[1,1,0] neg_lo:[0,0,1] neg_hi:[0,0,1]
    v_cvt_pk_bf16_f32 v68, v48, v49
    v_pk_fma_f32 v[52:53], v[28:29], v[72:73], v[72:73] op_sel:[0,1,0] op_sel_hi:[1,1,0] neg_lo:[0,0,1] neg_hi:[0,0,1]
    v_cvt_pk_bf16_f32 v69, v50, v51
    v_pk_fma_f32 v[54:55], v[30:31], v[72:73], v[72:73] op_sel:[0,1,0] op_sel_hi:[1,1,0] neg_lo:[0,0,1] neg_hi:[0,0,1]
    v_cvt_pk_bf16_f32 v70, v52, v53
    v_cvt_pk_bf16_f32 v71, v54, v55
    ds_write_b128 v12, v[68:71] offset:8320
    s_waitcnt vmcnt(10)
    v_mul_f32 v148, s81, v148
    v_mul_f32 v144, s81, v144
    v_exp_f32 v148, v148
    v_exp_f32 v144, v144
    s_bfe_u32 s82, s4, 0x10001
    s_mul_i32 s82, s82, 31008
    v_cvt_pk_bf16_f32 v148, 0, v148
    v_cvt_pk_bf16_f32 v144, 0, v144
    s_and_b32 s83, s4, 1
    s_lshl_b32 s83, s83, 8
    v_mul_f32 v64, v144, v148
    v_mul_f32 v65, v145, v148
    v_mul_f32 v64, 0xbfb8aa3b, v64
    v_mul_f32 v65, 0.15915494, v65
    v_add_f32 v148, v148, v148
    s_add_u32 s82, s82, s83
    s_add_u32 m0, s82, 5376
    v_mul_f32 v66, v146, v148
    v_mul_f32 v67, v147, v148
    s_cmp_ge_u32 s4, 4
    s_cbranch_scc1 L_rho1_5
    v_mul_f32 v68, 0x41000000, v64
    v_mul_f32 v69, 0x41000000, v65
    v_exp_f32 v68, v68
    v_fract_f32 v69, v69
    v_cos_f32 v72, v69
    v_sin_f32 v73, v69
    v_mul_f32 v72, v72, v68
    v_mul_f32 v73, v73, -v68
    v_mul_f32 v68, 0x43000000, v64
    v_mul_f32 v69, 0x43000000, v65
    v_exp_f32 v68, v68
    v_fract_f32 v69, v69
    v_cos_f32 v74, v69
    v_sin_f32 v75, v69
    v_mul_f32 v74, v74, v68
    v_mul_f32 v75, v75, v68
    v_mul_f32 v68, 0x44800000, v64
    v_mul_f32 v69, 0x44800000, v65
    v_exp_f32 v68, v68
    v_fract_f32 v69, v69
    v_cos_f32 v78, v69
    v_sin_f32 v79, v69
    v_mul_f32 v78, v78, v68
    v_mul_f32 v79, v79, v68
    v_mov_b32 v70, 0x3f80
    ds_write_addtid_b32 v70 offset:0
    v_cvt_pk_bf16_f32 v71, v72, v73
    ds_write_addtid_b32 v71 offset:544
    v_pk_mul_f32 v[68:69], v[78:79], v[66:67] op_sel_hi:[0,1]
    v_pk_fma_f32 v[78:79], v[78:79], v[66:67], v[68:69] op_sel:[1,1,0] op_sel_hi:[1,0,1] neg_lo:[1,0,0]
    v_cvt_pk_bf16_f32 v70, v78, v79
    ds_write_addtid_b32 v70 offset:26112
    v_pk_mul_f32 v[68:69], v[72:73], v[72:73] op_sel_hi:[0,1]
    v_pk_fma_f32 v[76:77], v[72:73], v[72:73], v[68:69] op_sel:[1,1,0] op_sel_hi:[1,0,1] neg_lo:[1,0,0]
    v_cvt_pk_bf16_f32 v71, v76, v77
    ds_write_addtid_b32 v71 offset:1088
    v_mov_b32 v95, 1
    v_mov_b32 v96, 2640
    s_waitcnt vmcnt(9)
    s_mov_b64 exec, 1
    ds_add_rtn_u32 v97, v96, v95
    s_mov_b64 exec, -1
    v_pk_mul_f32 v[80:81], v[78:79], v[74:75] op_sel_hi:[0,1]
    v_pk_fma_f32 v[78:79], v[78:79], v[74:75], v[80:81] op_sel:[1,1,0] op_sel_hi:[1,0,1] neg_lo:[1,0,0]
    v_cvt_pk_bf16_f32 v70, v78, v79
    ds_write_addtid_b32 v70 offset:26656
    v_pk_mul_f32 v[68:69], v[76:77], v[72:73] op_sel_hi:[0,1]
    v_pk_fma_f32 v[76:77], v[76:77], v[72:73], v[68:69] op_sel:[1,1,0] op_sel_hi:[1,0,1] neg_lo:[1,0,0]
    v_cvt_pk_bf16_f32 v71, v76, v77
    ds_write_addtid_b32 v71 offset:1632
    s_waitcnt lgkmcnt(2)
    v_readfirstlane_b32 s82, v97
    s_nop 0
    s_cmp_lg_u32 s82, 7
    s_cbranch_scc1 L_arr_11
    s_and_b32 s82, s2, 15
    s_lshl_b32 s82, s82, 2
    s_bfe_u32 s83, s2, 0x10004
    s_lshl_b32 s83, s83, 7
    s_add_u32 s82, s82, s83
    s_mov_b64 exec, 1
    buffer_atomic_add v95, off, s[16:19], s82 sc1
    s_mov_b64 exec, -1
L_arr_11:
    v_pk_mul_f32 v[80:81], v[78:79], v[74:75] op_sel_hi:[0,1]
    v_pk_fma_f32 v[78:79], v[78:79], v[74:75], v[80:81] op_sel:[1,1,0] op_sel_hi:[1,0,1] neg_lo:[1,0,0]
    v_cvt_pk_bf16_f32 v70, v78, v79
    ds_write_addtid_b32 v70 offset:27200
    v_pk_mul_f32 v[68:69], v[76:77], v[72:73] op_sel_hi:[0,1]
    v_pk_fma_f32 v[76:77], v[76:77], v[72:73], v[68:69] op_sel:[1,1,0] op_sel_hi:[1,0,1] neg_lo:[1,0,0]
    v_cvt_pk_bf16_f32 v71, v76, v77
    ds_write_addtid_b32 v71 offset:2176
    v_pk_mul_f32 v[80:81], v[78:79], v[74:75] op_sel_hi:[0,1]
    v_pk_fma_f32 v[78:79], v[78:79], v[74:75], v[80:81] op_sel:[1,1,0] op_sel_hi:[1,0,1] neg_lo:[1,0,0]
    v_cvt_pk_bf16_f32 v70, v78, v79
    ds_write_addtid_b32 v70 offset:27744
    v_pk_mul_f32 v[68:69], v[76:77], v[72:73] op_sel_hi:[0,1]
    v_pk_fma_f32 v[76:77], v[76:77], v[72:73], v[68:69] op_sel:[1,1,0] op_sel_hi:[1,0,1] neg_lo:[1,0,0]
    v_cvt_pk_bf16_f32 v71, v76, v77
    ds_write_addtid_b32 v71 offset:2720
    v_pk_mul_f32 v[80:81], v[78:79], v[74:75] op_sel_hi:[0,1]
    v_pk_fma_f32 v[78:79], v[78:79], v[74:75], v[80:81] op_sel:[1,1,0] op_sel_hi:[1,0,1] neg_lo:[1,0,0]
    v_cvt_pk_bf16_f32 v70, v78, v79
    ds_write_addtid_b32 v70 offset:28288
    v_pk_mul_f32 v[68:69], v[76:77], v[72:73] op_sel_hi:[0,1]
    v_pk_fma_f32 v[76:77], v[76:77], v[72:73], v[68:69] op_sel:[1,1,0] op_sel_hi:[1,0,1] neg_lo:[1,0,0]
    v_cvt_pk_bf16_f32 v71, v76, v77
    ds_write_addtid_b32 v71 offset:3264
    v_pk_mul_f32 v[80:81], v[78:79], v[74:75] op_sel_hi:[0,1]
    v_pk_fma_f32 v[78:79], v[78:79], v[74:75], v[80:81] op_sel:[1,1,0] op_sel_hi:[1,0,1] neg_lo:[1,0,0]
    v_cvt_pk_bf16_f32 v70, v78, v79
    ds_write_addtid_b32 v70 offset:28832
    v_pk_mul_f32 v[68:69], v[76:77], v[72:73] op_sel_hi:[0,1]
    v_pk_fma_f32 v[76:77], v[76:77], v[72:73], v[68:69] op_sel:[1,1,0] op_sel_hi:[1,0,1] neg_lo:[1,0,0]
    v_cvt_pk_bf16_f32 v71, v76, v77
    ds_write_addtid_b32 v71 offset:3808
    v_pk_mul_f32 v[80:81], v[78:79], v[74:75] op_sel_hi:[0,1]
    v_pk_fma_f32 v[78:79], v[78:79], v[74:75], v[80:81] op_sel:[1,1,0] op_sel_hi:[1,0,1] neg_lo:[1,0,0]
    v_cvt_pk_bf16_f32 v70, v78, v79
    ds_write_addtid_b32 v70 offset:29376
    v_pk_mul_f32 v[68:69], v[76:77], v[72:73] op_sel_hi:[0,1]
    v_pk_fma_f32 v[76:77], v[76:77], v[72:73], v[68:69] op_sel:[1,1,0] op_sel_hi:[1,0,1] neg_lo:[1,0,0]
    v_cvt_pk_bf16_f32 v71, v76, v77
    ds_write_addtid_b32 v71 offset:4352
    v_pk_mul_f32 v[80:81], v[78:79], v[74:75] op_sel_hi:[0,1]
    v_pk_fma_f32 v[78:79], v[78:79], v[74:75], v[80:81] op_sel:[1,1,0] op_sel_hi:[1,0,1] neg_lo:[1,0,0]
    v_cvt_pk_bf16_f32 v70, v78, v79
    ds_write_addtid_b32 v70 offset:29920
    v_pk_mul_f32 v[68:69], v[76:77], v[72:73] op_sel_hi:[0,1]
    v_pk_fma_f32 v[76:77], v[76:77], v[72:73], v[68:69] op_sel:[1,1,0] op_sel_hi:[1,0,1] neg_lo:[1,0,0]
    v_cvt_pk_bf16_f32 v71, v76, v77
    ds_write_addtid_b32 v71 offset:4896
    v_pk_mul_f32 v[80:81], v[78:79], v[74:75] op_sel_hi:[0,1]
    v_pk_fma_f32 v[78:79], v[78:79], v[74:75], v[80:81] op_sel:[1,1,0] op_sel_hi:[1,0,1] neg_lo:[1,0,0]
    v_cvt_pk_bf16_f32 v70, v78, v79
    ds_write_addtid_b32 v70 offset:30464
    v_pk_mul_f32 v[68:69], v[76:77], v[72:73] op_sel_hi:[0,1]
    v_pk_fma_f32 v[76:77], v[76:77], v[72:73], v[68:69] op_sel:[1,1,0] op_sel_hi:[1,0,1] neg_lo:[1,0,0]
    v_cvt_pk_bf16_f32 v71, v76, v77
    ds_write_addtid_b32 v71 offset:5440
    v_pk_mul_f32 v[68:69], v[76:77], v[72:73] op_sel_hi:[0,1]
    v_pk_fma_f32 v[76:77], v[76:77], v[72:73], v[68:69] op_sel:[1,1,0] op_sel_hi:[1,0,1] neg_lo:[1,0,0]
    v_cvt_pk_bf16_f32 v70, v76, v77
    ds_write_addtid_b32 v70 offset:5984
    v_pk_mul_f32 v[68:69], v[76:77], v[72:73] op_sel_hi:[0,1]
    v_pk_fma_f32 v[76:77], v[76:77], v[72:73], v[68:69] op_sel:[1,1,0] op_sel_hi:[1,0,1] neg_lo:[1,0,0]
    v_cvt_pk_bf16_f32 v71, v76, v77
    ds_write_addtid_b32 v71 offset:6528
    v_pk_mul_f32 v[68:69], v[76:77], v[72:73] op_sel_hi:[0,1]
    v_pk_fma_f32 v[76:77], v[76:77], v[72:73], v[68:69] op_sel:[1,1,0] op_sel_hi:[1,0,1] neg_lo:[1,0,0]
    v_cvt_pk_bf16_f32 v70, v76, v77
    ds_write_addtid_b32 v70 offset:7072
    v_pk_mul_f32 v[68:69], v[76:77], v[72:73] op_sel_hi:[0,1]
    v_pk_fma_f32 v[76:77], v[76:77], v[72:73], v[68:69] op_sel:[1,1,0] op_sel_hi:[1,0,1] neg_lo:[1,0,0]
    v_cvt_pk_bf16_f32 v71, v76, v77
    ds_write_addtid_b32 v71 offset:7616
    v_pk_mul_f32 v[68:69], v[76:77], v[72:73] op_sel_hi:[0,1]
    v_pk_fma_f32 v[76:77], v[76:77], v[72:73], v[68:69] op_sel:[1,1,0] op_sel_hi:[1,0,1] neg_lo:[1,0,0]
    v_cvt_pk_bf16_f32 v70, v76, v77
    ds_write_addtid_b32 v70 offset:8160
    v_mul_f32 v68, 0x40800000, v64
    v_mul_f32 v69, 0x40800000, v65
    v_exp_f32 v68, v68
    v_fract_f32 v69, v69
    v_cos_f32 v84, v69
    v_sin_f32 v85, v69
    v_mul_f32 v84, v84, v68
    v_mul_f32 v85, v85, v68
    v_mul_f32 v68, 0x43800000, v64
    v_mul_f32 v69, 0x43800000, v65
    v_exp_f32 v68, v68
    v_fract_f32 v69, v69
    v_cos_f32 v78, v69
    v_sin_f32 v79, v69
    v_mul_f32 v78, v78, v68
    v_mul_f32 v79, v79, v68
    v_mul_f32 v68, 0x44000000, v64
    v_mul_f32 v69, 0x44000000, v65
    v_exp_f32 v68, v68
    v_fract_f32 v69, v69
    v_cos_f32 v88, v69
    v_sin_f32 v89, v69
    v_mul_f32 v88, v88, v68
    v_mul_f32 v89, v89, v68
    v_pk_mul_f32 v[68:69], v[78:79], v[66:67] op_sel_hi:[0,1]
    v_pk_fma_f32 v[78:79], v[78:79], v[66:67], v[68:69] op_sel:[1,1,0] op_sel_hi:[1,0,1] neg_lo:[1,0,0]
    v_pk_mul_f32 v[68:69], v[78:79], v[88:89] op_sel_hi:[0,1]
    v_pk_fma_f32 v[78:79], v[78:79], v[88:89], v[68:69] op_sel:[1,1,0] op_sel_hi:[1,0,1] neg_lo:[1,0,0]
    v_cvt_pk_bf16_f32 v71, v78, v79
    ds_write_addtid_b32 v71 offset:23936
    v_pk_mul_f32 v[80:81], v[78:79], v[84:85] op_sel_hi:[0,1]
    v_pk_fma_f32 v[76:77], v[78:79], v[84:85], v[80:81] op_sel:[1,1,0] op_sel_hi:[1,0,1] neg_lo:[1,0,0]
    v_cvt_pk_bf16_f32 v70, v76, v77
    ds_write_addtid_b32 v70 offset:24480
    v_pk_mul_f32 v[68:69], v[78:79], v[74:75] op_sel_hi:[0,1]
    v_pk_fma_f32 v[78:79], v[78:79], v[74:75], v[68:69] op_sel:[1,1,0] op_sel_hi:[1,0,1] neg_lo:[1,0,0]
    v_cvt_pk_bf16_f32 v71, v78, v79
    ds_write_addtid_b32 v71 offset:25024
    v_pk_mul_f32 v[80:81], v[76:77], v[74:75] op_sel_hi:[0,1]
    v_pk_fma_f32 v[76:77], v[76:77], v[74:75], v[80:81] op_sel:[1,1,0] op_sel_hi:[1,0,1] neg_lo:[1,0,0]
    v_cvt_pk_bf16_f32 v70, v76, v77
    ds_write_addtid_b32 v70 offset:25568
    s_branch L_rhoe_6
L_rho1_5:
    v_mul_f32 v68, 0x3f800000, v64
    v_mul_f32 v69, 0x3f800000, v65
    v_exp_f32 v68, v68
    v_fract_f32 v69, v69
    v_cos_f32 v72, v69
    v_sin_f32 v73, v69
    v_mul_f32 v72, v72, v68
    v_mul_f32 v73, v73, v68
    v_mul_f32 v68, 0x43000000, v64
    v_mul_f32 v69, 0x43000000, v65
    v_exp_f32 v68, v68
    v_fract_f32 v69, v69
    v_cos_f32 v74, v69
    v_sin_f32 v75, v69
    v_mul_f32 v74, v74, v68
    v_mul_f32 v75, v75, v68
    v_cvt_pk_bf16_f32 v71, v66, v67
    ds_write_addtid_b32 v71 offset:8704
    v_pk_mul_f32 v[68:69], v[66:67], v[74:75] op_sel_hi:[0,1]
    v_pk_fma_f32 v[78:79], v[66:67], v[74:75], v[68:69] op_sel:[1,1,0] op_sel_hi:[1,0,1] neg_lo:[1,0,0]
    v_cvt_pk_bf16_f32 v70, v78, v79
    ds_write_addtid_b32 v70 offset:13056
    v_pk_mul_f32 v[68:69], v[66:67], v[72:73] op_sel_hi:[0,1]
    v_pk_fma_f32 v[76:77], v[66:67], v[72:73], v[68:69] op_sel:[1,1,0] op_sel_hi:[1,0,1] neg_lo:[1,0,0]
    v_cvt_pk_bf16_f32 v71, v76, v77
    ds_write_addtid_b32 v71 offset:9248
    v_mov_b32 v95, 1
    v_mov_b32 v96, 2640
    s_waitcnt vmcnt(9)
    s_mov_b64 exec, 1
    ds_add_rtn_u32 v97, v96, v95
    s_mov_b64 exec, -1
    v_pk_mul_f32 v[80:81], v[78:79], v[72:73] op_sel_hi:[0,1]
    v_pk_fma_f32 v[78:79], v[78:79], v[72:73], v[80:81] op_sel:[1,1,0] op_sel_hi:[1,0,1] neg_lo:[1,0,0]
    v_cvt_pk_bf16_f32 v70, v78, v79
    ds_write_addtid_b32 v70 offset:13600
    v_pk_mul_f32 v[68:69], v[76:77], v[72:73] op_sel_hi:[0,1]
    v_pk_fma_f32 v[76:77], v[76:77], v[72:73], v[68:69] op_sel:[1,1,0] op_sel_hi:[1,0,1] neg_lo:[1,0,0]
    v_cvt_pk_bf16_f32 v71, v76, v77
    ds_write_addtid_b32 v71 offset:9792
    s_waitcnt lgkmcnt(2)
    v_readfirstlane_b32 s82, v97
    s_nop 0
    s_cmp_lg_u32 s82, 7
    s_cbranch_scc1 L_arr_16
    s_and_b32 s82, s2, 15
    s_lshl_b32 s82, s82, 2
    s_bfe_u32 s83, s2, 0x10004
    s_lshl_b32 s83, s83, 7
    s_add_u32 s82, s82, s83
    s_mov_b64 exec, 1
    buffer_atomic_add v95, off, s[16:19], s82 sc1
    s_mov_b64 exec, -1
L_arr_16:
    v_pk_mul_f32 v[80:81], v[78:79], v[72:73] op_sel_hi:[0,1]
    v_pk_fma_f32 v[78:79], v[78:79], v[72:73], v[80:81] op_sel:[1,1,0] op_sel_hi:[1,0,1] neg_lo:[1,0,0]
    v_cvt_pk_bf16_f32 v70, v78, v79
    ds_write_addtid_b32 v70 offset:14144
    v_pk_mul_f32 v[68:69], v[76:77], v[72:73] op_sel_hi:[0,1]
    v_pk_fma_f32 v[76:77], v[76:77], v[72:73], v[68:69] op_sel:[1,1,0] op_sel_hi:[1,0,1] neg_lo:[1,0,0]
    v_cvt_pk_bf16_f32 v71, v76, v77
    ds_write_addtid_b32 v71 offset:10336
    v_pk_mul_f32 v[80:81], v[78:79], v[72:73] op_sel_hi:[0,1]
    v_pk_fma_f32 v[78:79], v[78:79], v[72:73], v[80:81] op_sel:[1,1,0] op_sel_hi:[1,0,1] neg_lo:[1,0,0]
    v_cvt_pk_bf16_f32 v70, v78, v79
    ds_write_addtid_b32 v70 offset:14688
    v_pk_mul_f32 v[68:69], v[76:77], v[72:73] op_sel_hi:[0,1]
    v_pk_fma_f32 v[76:77], v[76:77], v[72:73], v[68:69] op_sel:[1,1,0] op_sel_hi:[1,0,1] neg_lo:[1,0,0]
    v_cvt_pk_bf16_f32 v71, v76, v77
    ds_write_addtid_b32 v71 offset:10880
    v_pk_mul_f32 v[80:81], v[78:79], v[72:73] op_sel_hi:[0,1]
    v_pk_fma_f32 v[78:79], v[78:79], v[72:73], v[80:81] op_sel:[1,1,0] op_sel_hi:[1,0,1] neg_lo:[1,0,0]
    v_cvt_pk_bf16_f32 v70, v78, v79
    ds_write_addtid_b32 v70 offset:15232
    v_pk_mul_f32 v[68:69], v[76:77], v[72:73] op_sel_hi:[0,1]
    v_pk_fma_f32 v[76:77], v[76:77], v[72:73], v[68:69] op_sel:[1,1,0] op_sel_hi:[1,0,1] neg_lo:[1,0,0]
    v_cvt_pk_bf16_f32 v71, v76, v77
    ds_write_addtid_b32 v71 offset:11424
    v_pk_mul_f32 v[80:81], v[78:79], v[72:73] op_sel_hi:[0,1]
    v_pk_fma_f32 v[78:79], v[78:79], v[72:73], v[80:81] op_sel:[1,1,0] op_sel_hi:[1,0,1] neg_lo:[1,0,0]
    v_cvt_pk_bf16_f32 v70, v78, v79
    ds_write_addtid_b32 v70 offset:15776
    v_pk_mul_f32 v[68:69], v[76:77], v[72:73] op_sel_hi:[0,1]
    v_pk_fma_f32 v[76:77], v[76:77], v[72:73], v[68:69] op_sel:[1,1,0] op_sel_hi:[1,0,1] neg_lo:[1,0,0]
    v_cvt_pk_bf16_f32 v71, v76, v77
    ds_write_addtid_b32 v71 offset:11968
    v_pk_mul_f32 v[80:81], v[78:79], v[72:73] op_sel_hi:[0,1]
    v_pk_fma_f32 v[78:79], v[78:79], v[72:73], v[80:81] op_sel:[1,1,0] op_sel_hi:[1,0,1] neg_lo:[1,0,0]
    v_cvt_pk_bf16_f32 v70, v78, v79
    ds_write_addtid_b32 v70 offset:16320
    v_pk_mul_f32 v[68:69], v[76:77], v[72:73] op_sel_hi:[0,1]
    v_pk_fma_f32 v[76:77], v[76:77], v[72:73], v[68:69] op_sel:[1,1,0] op_sel_hi:[1,0,1] neg_lo:[1,0,0]
    v_cvt_pk_bf16_f32 v71, v76, v77
    ds_write_addtid_b32 v71 offset:12512
    v_pk_mul_f32 v[80:81], v[78:79], v[72:73] op_sel_hi:[0,1]
    v_pk_fma_f32 v[78:79], v[78:79], v[72:73], v[80:81] op_sel:[1,1,0] op_sel_hi:[1,0,1] neg_lo:[1,0,0]
    v_cvt_pk_bf16_f32 v70, v78, v79
    ds_write_addtid_b32 v70 offset:16864
    v_mul_f32 v68, v73, v73
    v_add_f32 v69, v72, v72
    v_fma_f32 v82, v72, v72, -v68
    v_mul_f32 v83, v69, v73
    v_mul_f32 v80, v75, v75
    v_add_f32 v81, v74, v74
    v_fma_f32 v86, v74, v74, -v80
    v_mul_f32 v87, v81, v75
    v_mul_f32 v68, v83, v83
    v_add_f32 v69, v82, v82
    v_fma_f32 v84, v82, v82, -v68
    v_mul_f32 v85, v69, v83
    v_pk_mul_f32 v[68:69], v[66:67], v[86:87] op_sel_hi:[0,1]
    v_pk_fma_f32 v[90:91], v[66:67], v[86:87], v[68:69] op_sel:[1,1,0] op_sel_hi:[1,0,1] neg_lo:[1,0,0]
    v_cvt_pk_bf16_f32 v71, v90, v91
    ds_write_addtid_b32 v71 offset:17408
    v_pk_mul_f32 v[80:81], v[90:91], v[74:75] op_sel_hi:[0,1]
    v_pk_fma_f32 v[92:93], v[90:91], v[74:75], v[80:81] op_sel:[1,1,0] op_sel_hi:[1,0,1] neg_lo:[1,0,0]
    v_cvt_pk_bf16_f32 v70, v92, v93
    ds_write_addtid_b32 v70 offset:19584
    v_pk_mul_f32 v[68:69], v[90:91], v[86:87] op_sel_hi:[0,1]
    v_pk_fma_f32 v[76:77], v[90:91], v[86:87], v[68:69] op_sel:[1,1,0] op_sel_hi:[1,0,1] neg_lo:[1,0,0]
    v_cvt_pk_bf16_f32 v71, v76, v77
    ds_write_addtid_b32 v71 offset:21760
    v_pk_mul_f32 v[80:81], v[76:77], v[84:85] op_sel_hi:[0,1]
    v_pk_fma_f32 v[78:79], v[76:77], v[84:85], v[80:81] op_sel:[1,1,0] op_sel_hi:[1,0,1] neg_lo:[1,0,0]
    v_cvt_pk_bf16_f32 v70, v78, v79
    ds_write_addtid_b32 v70 offset:22304
    v_pk_mul_f32 v[68:69], v[90:91], v[82:83] op_sel_hi:[0,1]
    v_pk_fma_f32 v[90:91], v[90:91], v[82:83], v[68:69] op_sel:[1,1,0] op_sel_hi:[1,0,1] neg_lo:[1,0,0]
    v_cvt_pk_bf16_f32 v71, v90, v91
    ds_write_addtid_b32 v71 offset:17952
    v_pk_mul_f32 v[80:81], v[92:93], v[82:83] op_sel_hi:[0,1]
    v_pk_fma_f32 v[92:93], v[92:93], v[82:83], v[80:81] op_sel:[1,1,0] op_sel_hi:[1,0,1] neg_lo:[1,0,0]
    v_cvt_pk_bf16_f32 v70, v92, v93
    ds_write_addtid_b32 v70 offset:20128
    v_pk_mul_f32 v[68:69], v[90:91], v[82:83] op_sel_hi:[0,1]
    v_pk_fma_f32 v[90:91], v[90:91], v[82:83], v[68:69] op_sel:[1,1,0] op_sel_hi:[1,0,1] neg_lo:[1,0,0]
    v_cvt_pk_bf16_f32 v71, v90, v91
    ds_write_addtid_b32 v71 offset:18496
    v_pk_mul_f32 v[80:81], v[92:93], v[82:83] op_sel_hi:[0,1]
    v_pk_fma_f32 v[92:93], v[92:93], v[82:83], v[80:81] op_sel:[1,1,0] op_sel_hi:[1,0,1] neg_lo:[1,0,0]
    v_cvt_pk_bf16_f32 v70, v92, v93
    ds_write_addtid_b32 v70 offset:20672
    v_pk_mul_f32 v[68:69], v[90:91], v[82:83] op_sel_hi:[0,1]
    v_pk_fma_f32 v[90:91], v[90:91], v[82:83], v[68:69] op_sel:[1,1,0] op_sel_hi:[1,0,1] neg_lo:[1,0,0]
    v_cvt_pk_bf16_f32 v71, v90, v91
    ds_write_addtid_b32 v71 offset:19040
    v_pk_mul_f32 v[80:81], v[92:93], v[82:83] op_sel_hi:[0,1]
    v_pk_fma_f32 v[92:93], v[92:93], v[82:83], v[80:81] op_sel:[1,1,0] op_sel_hi:[1,0,1] neg_lo:[1,0,0]
    v_cvt_pk_bf16_f32 v70, v92, v93
    ds_write_addtid_b32 v70 offset:21216
    v_pk_mul_f32 v[68:69], v[76:77], v[74:75] op_sel_hi:[0,1]
    v_pk_fma_f32 v[76:77], v[76:77], v[74:75], v[68:69] op_sel:[1,1,0] op_sel_hi:[1,0,1] neg_lo:[1,0,0]
    v_cvt_pk_bf16_f32 v71, v76, v77
    ds_write_addtid_b32 v71 offset:22848
    v_pk_mul_f32 v[80:81], v[78:79], v[74:75] op_sel_hi:[0,1]
    v_pk_fma_f32 v[78:79], v[78:79], v[74:75], v[80:81] op_sel:[1,1,0] op_sel_hi:[1,0,1] neg_lo:[1,0,0]
    v_cvt_pk_bf16_f32 v70, v78, v79
    ds_write_addtid_b32 v70 offset:23392
L_rhoe_6:
    s_waitcnt vmcnt(8)
    s_waitcnt lgkmcnt(0)
    s_barrier
L_ca_17:
    ds_read_u16_d16 v96, v11 offset:8320
    ds_read_u16_d16_hi v100, v11 offset:9360
    ds_read_u16_d16 v97, v11 offset:10400
    ds_read_u16_d16_hi v101, v11 offset:11440
    ds_read_u16_d16 v98, v11 offset:12480
    ds_read_u16_d16_hi v102, v11 offset:13520
    ds_read_u16_d16 v99, v11 offset:14560
    ds_read_u16_d16_hi v103, v11 offset:15600
    s_waitcnt lgkmcnt(6)
    v_or3_b32 v104, v96, v100, 1
    s_waitcnt lgkmcnt(4)
    v_or3_b32 v105, v97, v101, 1
    s_waitcnt lgkmcnt(2)
    v_or3_b32 v106, v98, v102, 1
    s_waitcnt lgkmcnt(0)
    v_or3_b32 v107, v99, v103, 1
    buffer_store_dwordx4 v[104:107], v4, s[8:11], 0 offen sc1
    s_and_b32 s83, s4, 3
    s_cmp_lg_u32 s83, 3
    s_cbranch_scc1 L_kgo_19
    buffer_load_short_d16_hi v152, v21, s[44:47], 0 offen offset:0
    buffer_load_short_d16_hi v153, v21, s[44:47], 0 offen offset:32
    buffer_load_short_d16_hi v154, v21, s[44:47], 0 offen offset:64
    buffer_load_short_d16_hi v155, v21, s[44:47], 0 offen offset:96
    buffer_load_short_d16_hi v156, v21, s[44:47], 0 offen offset:512
    buffer_load_short_d16_hi v157, v21, s[44:47], 0 offen offset:544
    buffer_load_short_d16_hi v158, v21, s[44:47], 0 offen offset:576
    buffer_load_short_d16_hi v159, v21, s[44:47], 0 offen offset:608
    s_branch L_kmm_18
L_kgo_19:
    ds_read_b128 v[64:67], v133 offset:0
    ds_read_b128 v[68:71], v132 offset:0
    ds_read_b128 v[72:75], v133 offset:64
    ds_read_b128 v[76:79], v132 offset:64
    ds_read_b128 v[80:83], v133 offset:128
    ds_read_b128 v[84:87], v132 offset:128
    ds_read_b128 v[88:91], v133 offset:192
    ds_read_b128 v[92:95], v132 offset:192
    s_waitcnt lgkmcnt(6)
    v_mfma_f32_16x16x32_bf16 v[140:143], v[64:67], v[68:71], 0
    ds_read_b128 v[64:67], v133 offset:256
    ds_read_b128 v[68:71], v132 offset:256
    buffer_load_short_d16_hi v152, v21, s[44:47], 0 offen offset:0
    s_waitcnt lgkmcnt(6)
    v_mfma_f32_16x16x32_bf16 v[140:143], v[72:75], v[76:79], v[140:143]
    ds_read_b128 v[72:75], v133 offset:320
    ds_read_b128 v[76:79], v132 offset:320
    buffer_load_short_d16_hi v153, v21, s[44:47], 0 offen offset:32
    s_waitcnt lgkmcnt(6)
    v_mfma_f32_16x16x32_bf16 v[140:143], v[80:83], v[84:87], v[140:143]
    ds_read_b128 v[80:83], v133 offset:384
    ds_read_b128 v[84:87], v132 offset:384
    buffer_load_short_d16_hi v154, v21, s[44:47], 0 offen offset:64
    s_waitcnt lgkmcnt(6)
    v_mfma_f32_16x16x32_bf16 v[140:143], v[88:91], v[92:95], v[140:143]
    ds_read_b128 v[88:91], v133 offset:448
    ds_read_b128 v[92:95], v132 offset:448
    buffer_load_short_d16_hi v155, v21, s[44:47], 0 offen offset:96
    s_waitcnt lgkmcnt(6)
    v_mfma_f32_16x16x32_bf16 v[140:143], v[64:67], v[68:71], v[140:143]
    buffer_load_short_d16_hi v156, v21, s[44:47], 0 offen offset:512
    s_waitcnt lgkmcnt(4)
    v_mfma_f32_16x16x32_bf16 v[140:143], v[72:75], v[76:79], v[140:143]
    buffer_load_short_d16_hi v157, v21, s[44:47], 0 offen offset:544
    s_waitcnt lgkmcnt(2)
    v_mfma_f32_16x16x32_bf16 v[140:143], v[80:83], v[84:87], v[140:143]
    buffer_load_short_d16_hi v158, v21, s[44:47], 0 offen offset:576
    s_waitcnt lgkmcnt(0)
    v_mfma_f32_16x16x32_bf16 v[140:143], v[88:91], v[92:95], v[140:143]
    buffer_load_short_d16_hi v159, v21, s[44:47], 0 offen offset:608
    s_nop 6
    ds_write_b32 v112, v140
    ds_write_b32 v113, v141
    ds_write_b32 v114, v142
    ds_write_b32 v115, v143
    s_cmp_lg_u32 s83, 2
    s_cbranch_scc1 L_kmm_18
    ds_write_b32 v56, v140
    ds_write_b32 v57, v141
    ds_write_b32 v58, v142
    ds_write_b32 v59, v143
L_kmm_18:
    s_waitcnt lgkmcnt(0)
    s_barrier
    s_cmp_eq_u32 s4, 7
    s_cbranch_scc1 L_xz_21
    s_cmp_gt_u32 s4, 4
    s_cbranch_scc1 L_xf_20
    s_cmp_eq_u32 s4, 4
    s_cselect_b64 exec, 15, -1
    ds_read_b32 v64, v116
    ds_read_b32 v65, v117
    ds_read_b32 v66, v118
    ds_read_b32 v67, v119
    ds_read_b32 v68, v120
    ds_read_b32 v69, v121
    ds_read_b32 v70, v122
    ds_read_b32 v71, v123
    ds_read_b32 v72, v124
    ds_read_b32 v73, v125
    ds_read_b32 v74, v126
    ds_read_b32 v75, v127
    ds_read_b32 v76, v128
    ds_read_b32 v77, v129
    ds_read_b32 v78, v130
    s_waitcnt lgkmcnt(3)
    v_cvt_pk_bf16_f32 v88, v64, v65
    v_cvt_pk_bf16_f32 v89, v66, v67
    v_cvt_pk_bf16_f32 v90, v68, v69
    v_cvt_pk_bf16_f32 v91, v70, v71
    v_cvt_pk_bf16_f32 v92, v72, v73
    v_cvt_pk_bf16_f32 v93, v74, v75
    ds_write_b128 v131, v[88:91] offset:0
    ds_write_b128 v131, v[90:93] offset:9472
    s_waitcnt lgkmcnt(2)
    v_cvt_pk_bf16_f32 v94, v66, v67
    v_cvt_pk_bf16_f32 v95, v68, v69
    v_cvt_pk_bf16_f32 v96, v70, v71
    v_cvt_pk_bf16_f32 v97, v72, v73
    v_cvt_pk_bf16_f32 v98, v74, v75
    v_cvt_pk_bf16_f32 v99, v76, v77
    ds_write_b128 v131, v[94:97] offset:4736
    ds_write_b128 v131, v[96:99] offset:14208
    v_cvt_pk_bf16_f32 v100, v65, v66
    v_cvt_pk_bf16_f32 v101, v67, v68
    v_cvt_pk_bf16_f32 v102, v69, v70
    v_cvt_pk_bf16_f32 v103, v71, v72
    v_cvt_pk_bf16_f32 v104, v73, v74
    v_cvt_pk_bf16_f32 v105, v75, v76
    ds_write_b128 v131, v[100:103] offset:2368
    ds_write_b128 v131, v[102:105] offset:11840
    v_cvt_pk_bf16_f32 v106, v67, v68
    v_cvt_pk_bf16_f32 v107, v69, v70
    v_cvt_pk_bf16_f32 v108, v71, v72
    v_cvt_pk_bf16_f32 v109, v73, v74
    v_cvt_pk_bf16_f32 v110, v75, v76
    v_cvt_pk_bf16_f32 v111, v77, v78
    ds_write_b128 v131, v[106:109] offset:7104
    ds_write_b128 v131, v[108:111] offset:16576
    s_mov_b64 exec, -1
    s_branch L_xe_22
L_xf_20:
    s_branch L_xe_22
L_xz_21:
    v_lshrrev_b32 v129, 5, v1
    v_mul_u32_u24 v129, 18944, v129
    v_bfe_u32 v128, v1, 2, 3
    v_mul_u32_u24 v128, 2368, v128
    v_add_u32 v129, v129, v128
    v_and_b32 v128, 3, v1
    v_lshl_add_u32 v128, v128, 4, v129
    ds_write_b128 v128, v[136:139] offset:5376
    ds_write_b128 v128, v[136:139] offset:7552
    v_and_b32 v128, 1, v1
    v_lshl_add_u32 v128, v128, 4, v129
    ds_write_b128 v128, v[136:139] offset:5440
L_xe_22:
    s_waitcnt vmcnt(9)
    v_or_b32 v32, v32, v36
    v_or_b32 v33, v33, v37
    v_or_b32 v34, v34, v38
    v_or_b32 v35, v35, v39
    ds_write_b128 v149, v[32:35]
    v_lshlrev_b32 v144, 4, v0
    s_lshl_b32 s82, s3, 13
    v_add_u32 v145, s82, v144
    v_add_u32 v144, 104544, v144
    s_cmp_lg_u32 s4, 4
    s_cbranch_scc1 L_sb_23
    v_and_b32 v84, 15, v1
    v_lshlrev_b32 v84, 2, v84
    v_and_b32 v85, 16, v1
    v_lshl_add_u32 v84, v85, 3, v84
    s_mov_b32 s80, 0
L_bp_24:
    buffer_load_dword v85, v84, s[16:19], 0 offen sc1
    s_waitcnt vmcnt(0)
    v_cmp_gt_u32 vcc, 8, v85
    s_nop 0
    s_cmp_eq_u64 vcc, 0
    s_cbranch_scc1 L_bd_25
    s_sleep 8
    s_add_u32 s80, s80, 1
    s_cmp_lt_u32 s80, 1048576
    s_cbranch_scc1 L_bp_24
    s_branch L_end
L_bd_25:
L_sb_23:
    s_waitcnt lgkmcnt(0)
    s_barrier
    buffer_load_dwordx4 v[132:135], v5, s[8:11], 0 offen sc1
    s_lshr_b32 s82, s4, 2
    s_mul_i32 s83, s82, 784
    s_bfe_u32 s84, s4, 0x10001
    s_mul_i32 s84, s84, 384
    s_add_u32 s83, s83, s84
    s_and_b32 s84, s4, 1
    s_lshl_b32 s84, s84, 2
    s_add_u32 s83, s83, s84
    s_add_u32 s83, s83, 71168
    v_lshlrev_b32 v146, 3, v2
    v_lshlrev_b32 v147, 4, v3
    v_sub_u32 v146, v146, v147
    v_add_u32 v146, s83, v146
    s_lshl_b32 s82, s4, 11
    s_add_u32 s82, s82, 43264
    v_lshl_add_u32 v147, v1, 4, s82
    ds_read_b32 v112, v146 offset:128
    ds_read_b32 v113, v146 offset:124
    ds_read_b32 v114, v146 offset:120
    ds_read_b32 v115, v146 offset:116
    ds_read_b32 v116, v146 offset:64
    ds_read_b32 v117, v146 offset:60
    ds_read_b32 v118, v146 offset:56
    ds_read_b32 v119, v146 offset:52
    ds_read_b32 v120, v146 offset:256
    ds_read_b32 v121, v146 offset:252
    ds_read_b32 v122, v146 offset:248
    ds_read_b32 v123, v146 offset:244
    ds_read_b32 v124, v146 offset:192
    ds_read_b32 v125, v146 offset:188
    ds_read_b32 v126, v146 offset:184
    ds_read_b32 v127, v146 offset:180
    s_waitcnt lgkmcnt(8)
    v_cvt_pk_bf16_f32 v80, v112, v113
    v_cvt_pk_bf16_f32 v81, v114, v115
    v_cvt_pk_bf16_f32 v82, v116, v117
    v_cvt_pk_bf16_f32 v83, v118, v119
    ds_write_b128 v147, v[80:83] offset:0
    s_waitcnt lgkmcnt(1)
    v_cvt_pk_bf16_f32 v84, v120, v121
    v_cvt_pk_bf16_f32 v85, v122, v123
    v_cvt_pk_bf16_f32 v86, v124, v125
    v_cvt_pk_bf16_f32 v87, v126, v127
    ds_write_b128 v147, v[84:87] offset:1024
    s_mov_b32 s80, 0
    s_branch L_u_check
L_layer:
    s_mov_b32 s80, 0
L_poll_u_26:
    buffer_load_dwordx4 v[132:135], v5, s[8:11], 0 offen sc1
L_u_check:
    s_waitcnt vmcnt(0)
    v_bitop3_b32 v151, v132, v134, 1 bitop3:0x2a
    v_cmp_ne_u32 vcc, 0, v151
    s_nop 0
    s_and_b64 exec, exec, vcc
    s_cbranch_scc0 L_done_u_27
    s_add_u32 s80, s80, 1
    s_cmp_lt_u32 s80, 1048576
    s_cbranch_scc1 L_poll_u_26
    s_mov_b64 exec, -1
    s_branch L_end
L_done_u_27:
    s_mov_b64 exec, -1
    ds_write_b128 v14, v[132:135]
    s_waitcnt lgkmcnt(0)
    s_barrier
    s_cmp_ge_u32 s4, 4
    s_cbranch_scc1 L_ci_30
    s_add_u32 s82, s4, 1
    s_bitcmp1_b32 s82, 1
    s_cbranch_scc1 L_cy_28
    s_setprio 1
    s_cmp_lg_u32 s71, 0
    s_cbranch_scc1 L_a0_31
    ds_read_b128 v[64:67], v15 offset:2144
    ds_read_b128 v[68:71], v15 offset:2112
    ds_read_b128 v[80:83], v15 offset:2080
    ds_read_b128 v[84:87], v15 offset:2048
    ds_read_b128 v[96:99], v15 offset:2016
    ds_read_b128 v[100:103], v15 offset:1984
L_a0_31:
    ds_read_b128 v[72:75], v16 offset:6048
    ds_read_b128 v[76:79], v16 offset:1440
    ds_read_b128 v[88:91], v16 offset:5952
    ds_read_b128 v[92:95], v16 offset:1344
    ds_read_b128 v[104:107], v16 offset:5856
    ds_read_b128 v[108:111], v16 offset:1248
    s_cmp_eq_u32 s71, 0
    s_cbranch_scc1 L_pw_32
    s_add_u32 s83, s60, 0
    v_mov_b32 v144, 0
    v_mov_b32 v145, 0
    v_mov_b32 v146, 0
    v_mov_b32 v147, 0
    buffer_store_dwordx4 v[144:147], v8, s[8:11], s83 offen sc1
    s_add_u32 s83, s60, 6144
    buffer_store_dwordx4 v[144:147], v8, s[8:11], s83 offen sc1
L_pw_32:
    s_waitcnt lgkmcnt(4)
    v_mfma_f32_16x16x32_bf16 v[128:131], v[64:67], v[72:75], 0
    ds_read_b128 v[112:115], v15 offset:1952
    v_mfma_f32_16x16x32_bf16 v[132:135], v[68:71], v[72:75], 0
    ds_read_b128 v[120:123], v16 offset:5760
    v_mfma_f32_16x16x32_bf16 v[136:139], v[64:67], v[76:79], 0
    ds_read_b128 v[116:119], v15 offset:1920
    v_mfma_f32_16x16x32_bf16 v[140:143], v[68:71], v[76:79], 0
    ds_read_b128 v[124:127], v16 offset:1152
    s_waitcnt lgkmcnt(6)
    v_mfma_f32_16x16x32_bf16 v[128:131], v[80:83], v[88:91], v[128:131]
    ds_read_b128 v[64:67], v15 offset:1888
    v_mfma_f32_16x16x32_bf16 v[132:135], v[84:87], v[88:91], v[132:135]
    ds_read_b128 v[72:75], v16 offset:5664
    v_mfma_f32_16x16x32_bf16 v[136:139], v[80:83], v[92:95], v[136:139]
    ds_read_b128 v[68:71], v15 offset:1856
    v_mfma_f32_16x16x32_bf16 v[140:143], v[84:87], v[92:95], v[140:143]
    ds_read_b128 v[76:79], v16 offset:1056
    s_waitcnt lgkmcnt(8)
    v_mfma_f32_16x16x32_bf16 v[128:131], v[96:99], v[104:107], v[128:131]
    ds_read_b128 v[80:83], v15 offset:1824
    v_mfma_f32_16x16x32_bf16 v[132:135], v[100:103], v[104:107], v[132:135]
    ds_read_b128 v[88:91], v16 offset:5568
    v_mfma_f32_16x16x32_bf16 v[136:139], v[96:99], v[108:111], v[136:139]
    ds_read_b128 v[84:87], v15 offset:1792
    v_mfma_f32_16x16x32_bf16 v[140:143], v[100:103], v[108:111], v[140:143]
    ds_read_b128 v[92:95], v16 offset:960
    s_waitcnt lgkmcnt(8)
    v_mfma_f32_16x16x32_bf16 v[128:131], v[112:115], v[120:123], v[128:131]
    ds_read_b128 v[96:99], v15 offset:1760
    v_mfma_f32_16x16x32_bf16 v[132:135], v[116:119], v[120:123], v[132:135]
    ds_read_b128 v[104:107], v16 offset:5472
    v_mfma_f32_16x16x32_bf16 v[136:139], v[112:115], v[124:127], v[136:139]
    ds_read_b128 v[100:103], v15 offset:1728
    v_mfma_f32_16x16x32_bf16 v[140:143], v[116:119], v[124:127], v[140:143]
    ds_read_b128 v[108:111], v16 offset:864
    s_waitcnt lgkmcnt(8)
    v_mfma_f32_16x16x32_bf16 v[128:131], v[64:67], v[72:75], v[128:131]
    ds_read_b128 v[112:115], v15 offset:1696
    v_mfma_f32_16x16x32_bf16 v[132:135], v[68:71], v[72:75], v[132:135]
    ds_read_b128 v[120:123], v16 offset:5376
    v_mfma_f32_16x16x32_bf16 v[136:139], v[64:67], v[76:79], v[136:139]
    ds_read_b128 v[116:119], v15 offset:1664
    v_mfma_f32_16x16x32_bf16 v[140:143], v[68:71], v[76:79], v[140:143]
    ds_read_b128 v[124:127], v16 offset:768
    s_waitcnt lgkmcnt(8)
    v_mfma_f32_16x16x32_bf16 v[128:131], v[80:83], v[88:91], v[128:131]
    ds_read_b128 v[64:67], v15 offset:1632
    v_mfma_f32_16x16x32_bf16 v[132:135], v[84:87], v[88:91], v[132:135]
    ds_read_b128 v[72:75], v16 offset:5280
    v_mfma_f32_16x16x32_bf16 v[136:139], v[80:83], v[92:95], v[136:139]
    ds_read_b128 v[68:71], v15 offset:1600
    v_mfma_f32_16x16x32_bf16 v[140:143], v[84:87], v[92:95], v[140:143]
    ds_read_b128 v[76:79], v16 offset:672
    s_waitcnt lgkmcnt(8)
    v_mfma_f32_16x16x32_bf16 v[128:131], v[96:99], v[104:107], v[128:131]
    ds_read_b128 v[80:83], v15 offset:1568
    v_mfma_f32_16x16x32_bf16 v[132:135], v[100:103], v[104:107], v[132:135]
    ds_read_b128 v[88:91], v16 offset:5184
    v_mfma_f32_16x16x32_bf16 v[136:139], v[96:99], v[108:111], v[136:139]
    ds_read_b128 v[84:87], v15 offset:1536
    v_mfma_f32_16x16x32_bf16 v[140:143], v[100:103], v[108:111], v[140:143]
    ds_read_b128 v[92:95], v16 offset:576
    s_waitcnt lgkmcnt(8)
    v_mfma_f32_16x16x32_bf16 v[128:131], v[112:115], v[120:123], v[128:131]
    ds_read_b128 v[96:99], v15 offset:1504
    v_mfma_f32_16x16x32_bf16 v[132:135], v[116:119], v[120:123], v[132:135]
    ds_read_b128 v[104:107], v16 offset:5088
    v_mfma_f32_16x16x32_bf16 v[136:139], v[112:115], v[124:127], v[136:139]
    ds_read_b128 v[100:103], v15 offset:1472
    v_mfma_f32_16x16x32_bf16 v[140:143], v[116:119], v[124:127], v[140:143]
    ds_read_b128 v[108:111], v16 offset:480
    s_waitcnt lgkmcnt(8)
    v_mfma_f32_16x16x32_bf16 v[128:131], v[64:67], v[72:75], v[128:131]
    ds_read_b128 v[112:115], v15 offset:1440
    v_mfma_f32_16x16x32_bf16 v[132:135], v[68:71], v[72:75], v[132:135]
    ds_read_b128 v[120:123], v16 offset:4992
    v_mfma_f32_16x16x32_bf16 v[136:139], v[64:67], v[76:79], v[136:139]
    ds_read_b128 v[116:119], v15 offset:1408
    v_mfma_f32_16x16x32_bf16 v[140:143], v[68:71], v[76:79], v[140:143]
    ds_read_b128 v[124:127], v16 offset:384
    s_waitcnt lgkmcnt(8)
    v_mfma_f32_16x16x32_bf16 v[128:131], v[80:83], v[88:91], v[128:131]
    ds_read_b128 v[64:67], v15 offset:1376
    v_mfma_f32_16x16x32_bf16 v[132:135], v[84:87], v[88:91], v[132:135]
    ds_read_b128 v[72:75], v16 offset:4896
    v_mfma_f32_16x16x32_bf16 v[136:139], v[80:83], v[92:95], v[136:139]
    ds_read_b128 v[68:71], v15 offset:1344
    v_mfma_f32_16x16x32_bf16 v[140:143], v[84:87], v[92:95], v[140:143]
    ds_read_b128 v[76:79], v16 offset:288
    s_waitcnt lgkmcnt(8)
    v_mfma_f32_16x16x32_bf16 v[128:131], v[96:99], v[104:107], v[128:131]
    ds_read_b128 v[80:83], v15 offset:1312
    v_mfma_f32_16x16x32_bf16 v[132:135], v[100:103], v[104:107], v[132:135]
    ds_read_b128 v[88:91], v16 offset:4800
    v_mfma_f32_16x16x32_bf16 v[136:139], v[96:99], v[108:111], v[136:139]
    ds_read_b128 v[84:87], v15 offset:1280
    v_mfma_f32_16x16x32_bf16 v[140:143], v[100:103], v[108:111], v[140:143]
    ds_read_b128 v[92:95], v16 offset:192
    s_waitcnt lgkmcnt(8)
    v_mfma_f32_16x16x32_bf16 v[128:131], v[112:115], v[120:123], v[128:131]
    ds_read_b128 v[96:99], v15 offset:1248
    v_mfma_f32_16x16x32_bf16 v[132:135], v[116:119], v[120:123], v[132:135]
    ds_read_b128 v[104:107], v16 offset:4704
    v_mfma_f32_16x16x32_bf16 v[136:139], v[112:115], v[124:127], v[136:139]
    ds_read_b128 v[100:103], v15 offset:1216
    v_mfma_f32_16x16x32_bf16 v[140:143], v[116:119], v[124:127], v[140:143]
    ds_read_b128 v[108:111], v16 offset:96
    s_waitcnt lgkmcnt(8)
    v_mfma_f32_16x16x32_bf16 v[128:131], v[64:67], v[72:75], v[128:131]
    ds_read_b128 v[112:115], v15 offset:1184
    v_mfma_f32_16x16x32_bf16 v[132:135], v[68:71], v[72:75], v[132:135]
    ds_read_b128 v[120:123], v16 offset:4608
    v_mfma_f32_16x16x32_bf16 v[136:139], v[64:67], v[76:79], v[136:139]
    ds_read_b128 v[116:119], v15 offset:1152
    v_mfma_f32_16x16x32_bf16 v[140:143], v[68:71], v[76:79], v[140:143]
    ds_read_b128 v[124:127], v16 offset:0
    s_waitcnt lgkmcnt(8)
    v_mfma_f32_16x16x32_bf16 v[128:131], v[80:83], v[88:91], v[128:131]
    v_mfma_f32_16x16x32_bf16 v[132:135], v[84:87], v[88:91], v[132:135]
    ds_read_b128 v[64:67], v15 offset:1120
    v_mfma_f32_16x16x32_bf16 v[136:139], v[80:83], v[92:95], v[136:139]
    ds_read_b128 v[72:75], v16 offset:4512
    v_mfma_f32_16x16x32_bf16 v[140:143], v[84:87], v[92:95], v[140:143]
    ds_read_b128 v[68:71], v15 offset:1088
    s_waitcnt lgkmcnt(7)
    v_mfma_f32_16x16x32_bf16 v[128:131], v[96:99], v[104:107], v[128:131]
    v_mfma_f32_16x16x32_bf16 v[132:135], v[100:103], v[104:107], v[132:135]
    ds_read_b128 v[80:83], v15 offset:1056
    v_mfma_f32_16x16x32_bf16 v[136:139], v[96:99], v[108:111], v[136:139]
    ds_read_b128 v[88:91], v16 offset:4416
    v_mfma_f32_16x16x32_bf16 v[140:143], v[100:103], v[108:111], v[140:143]
    ds_read_b128 v[84:87], v15 offset:1024
    s_waitcnt lgkmcnt(6)
    v_mfma_f32_16x16x32_bf16 v[128:131], v[112:115], v[120:123], v[128:131]
    v_mfma_f32_16x16x32_bf16 v[132:135], v[116:119], v[120:123], v[132:135]
    ds_read_b128 v[96:99], v15 offset:992
    v_mfma_f32_16x16x32_bf16 v[136:139], v[112:115], v[124:127], v[136:139]
    ds_read_b128 v[104:107], v16 offset:4320
    v_mfma_f32_16x16x32_bf16 v[140:143], v[116:119], v[124:127], v[140:143]
    ds_read_b128 v[100:103], v15 offset:960
    s_waitcnt lgkmcnt(6)
    v_mfma_f32_16x16x32_bf16 v[128:131], v[64:67], v[72:75], v[128:131]
    ds_read_b128 v[112:115], v15 offset:928
    v_mfma_f32_16x16x32_bf16 v[132:135], v[68:71], v[72:75], v[132:135]
    ds_read_b128 v[120:123], v16 offset:4224
    ds_read_b128 v[116:119], v15 offset:896
    s_waitcnt lgkmcnt(6)
    v_mfma_f32_16x16x32_bf16 v[128:131], v[80:83], v[88:91], v[128:131]
    ds_read_b128 v[64:67], v15 offset:864
    v_mfma_f32_16x16x32_bf16 v[132:135], v[84:87], v[88:91], v[132:135]
    ds_read_b128 v[72:75], v16 offset:4128
    ds_read_b128 v[68:71], v15 offset:832
    s_waitcnt lgkmcnt(6)
    v_mfma_f32_16x16x32_bf16 v[128:131], v[96:99], v[104:107], v[128:131]
    ds_read_b128 v[80:83], v15 offset:800
    v_mfma_f32_16x16x32_bf16 v[132:135], v[100:103], v[104:107], v[132:135]
    ds_read_b128 v[88:91], v16 offset:4032
    ds_read_b128 v[84:87], v15 offset:768
    v_cvt_pk_bf16_f32 v144, v136, v137
    v_cvt_pk_bf16_f32 v146, v140, v141
    v_cvt_pk_bf16_f32 v145, v138, v139
    v_cvt_pk_bf16_f32 v147, v142, v143
    s_add_u32 s82, s60, 0
    v_permlane16_swap_b32 v144, v146
    v_permlane16_swap_b32 v145, v147
    v_or_b32 v144, 1, v144
    v_or_b32 v146, 1, v146
    buffer_store_dwordx4 v[144:147], v8, s[8:11], s82 offen sc1
    s_waitcnt lgkmcnt(6)
    v_mfma_f32_16x16x32_bf16 v[128:131], v[112:115], v[120:123], v[128:131]
    ds_read_b128 v[96:99], v15 offset:736
    v_mfma_f32_16x16x32_bf16 v[132:135], v[116:119], v[120:123], v[132:135]
    ds_read_b128 v[104:107], v16 offset:3936
    ds_read_b128 v[100:103], v15 offset:704
    s_waitcnt lgkmcnt(6)
    v_mfma_f32_16x16x32_bf16 v[128:131], v[64:67], v[72:75], v[128:131]
    ds_read_b128 v[112:115], v15 offset:672
    v_mfma_f32_16x16x32_bf16 v[132:135], v[68:71], v[72:75], v[132:135]
    ds_read_b128 v[120:123], v16 offset:3840
    ds_read_b128 v[116:119], v15 offset:640
    s_waitcnt lgkmcnt(6)
    v_mfma_f32_16x16x32_bf16 v[128:131], v[80:83], v[88:91], v[128:131]
    ds_read_b128 v[64:67], v15 offset:608
    v_mfma_f32_16x16x32_bf16 v[132:135], v[84:87], v[88:91], v[132:135]
    ds_read_b128 v[72:75], v16 offset:3744
    ds_read_b128 v[68:71], v15 offset:576
    s_waitcnt lgkmcnt(6)
    v_mfma_f32_16x16x32_bf16 v[128:131], v[96:99], v[104:107], v[128:131]
    ds_read_b128 v[80:83], v15 offset:544
    v_mfma_f32_16x16x32_bf16 v[132:135], v[100:103], v[104:107], v[132:135]
    ds_read_b128 v[88:91], v16 offset:3648
    ds_read_b128 v[84:87], v15 offset:512
    s_waitcnt lgkmcnt(6)
    v_mfma_f32_16x16x32_bf16 v[128:131], v[112:115], v[120:123], v[128:131]
    ds_read_b128 v[96:99], v15 offset:480
    v_mfma_f32_16x16x32_bf16 v[132:135], v[116:119], v[120:123], v[132:135]
    ds_read_b128 v[104:107], v16 offset:3552
    ds_read_b128 v[100:103], v15 offset:448
    s_waitcnt lgkmcnt(6)
    v_mfma_f32_16x16x32_bf16 v[128:131], v[64:67], v[72:75], v[128:131]
    ds_read_b128 v[112:115], v15 offset:416
    v_mfma_f32_16x16x32_bf16 v[132:135], v[68:71], v[72:75], v[132:135]
    ds_read_b128 v[120:123], v16 offset:3456
    ds_read_b128 v[116:119], v15 offset:384
    s_waitcnt lgkmcnt(6)
    v_mfma_f32_16x16x32_bf16 v[128:131], v[80:83], v[88:91], v[128:131]
    ds_read_b128 v[64:67], v15 offset:352
    v_mfma_f32_16x16x32_bf16 v[132:135], v[84:87], v[88:91], v[132:135]
    ds_read_b128 v[72:75], v16 offset:3360
    ds_read_b128 v[68:71], v15 offset:320
    s_waitcnt lgkmcnt(6)
    v_mfma_f32_16x16x32_bf16 v[128:131], v[96:99], v[104:107], v[128:131]
    ds_read_b128 v[80:83], v15 offset:288
    v_mfma_f32_16x16x32_bf16 v[132:135], v[100:103], v[104:107], v[132:135]
    ds_read_b128 v[88:91], v16 offset:3264
    ds_read_b128 v[84:87], v15 offset:256
    s_waitcnt lgkmcnt(6)
    v_mfma_f32_16x16x32_bf16 v[128:131], v[112:115], v[120:123], v[128:131]
    ds_read_b128 v[96:99], v15 offset:224
    v_mfma_f32_16x16x32_bf16 v[132:135], v[116:119], v[120:123], v[132:135]
    ds_read_b128 v[104:107], v16 offset:3168
    ds_read_b128 v[100:103], v15 offset:192
    s_waitcnt lgkmcnt(6)
    v_mfma_f32_16x16x32_bf16 v[128:131], v[64:67], v[72:75], v[128:131]
    ds_read_b128 v[112:115], v15 offset:160
    v_mfma_f32_16x16x32_bf16 v[132:135], v[68:71], v[72:75], v[132:135]
    ds_read_b128 v[120:123], v16 offset:3072
    ds_read_b128 v[116:119], v15 offset:128
    s_waitcnt lgkmcnt(6)
    v_mfma_f32_16x16x32_bf16 v[128:131], v[80:83], v[88:91], v[128:131]
    ds_read_b128 v[64:67], v15 offset:96
    v_mfma_f32_16x16x32_bf16 v[132:135], v[84:87], v[88:91], v[132:135]
    ds_read_b128 v[72:75], v16 offset:2976
    ds_read_b128 v[68:71], v15 offset:64
    s_waitcnt lgkmcnt(6)
    v_mfma_f32_16x16x32_bf16 v[128:131], v[96:99], v[104:107], v[128:131]
    ds_read_b128 v[80:83], v15 offset:32
    v_mfma_f32_16x16x32_bf16 v[132:135], v[100:103], v[104:107], v[132:135]
    ds_read_b128 v[88:91], v16 offset:2880
    ds_read_b128 v[84:87], v15 offset:0
    s_waitcnt lgkmcnt(6)
    v_mfma_f32_16x16x32_bf16 v[128:131], v[112:115], v[120:123], v[128:131]
    ds_read_b32 v108, v23 offset:37764
    v_mfma_f32_16x16x32_bf16 v[132:135], v[116:119], v[120:123], v[132:135]
    ds_read_b128 v[96:99], v23 offset:2048
    ds_read_b128 v[100:103], v23 offset:3072
    s_waitcnt lgkmcnt(6)
    v_mfma_f32_16x16x32_bf16 v[128:131], v[64:67], v[72:75], v[128:131]
    v_mfma_f32_16x16x32_bf16 v[132:135], v[68:71], v[72:75], v[132:135]
    s_waitcnt lgkmcnt(3)
    v_mfma_f32_16x16x32_bf16 v[128:131], v[80:83], v[88:91], v[128:131]
    v_mfma_f32_16x16x32_bf16 v[132:135], v[84:87], v[88:91], v[132:135]
    s_add_u32 s83, s71, 1
    s_waitcnt lgkmcnt(0)
    v_cmp_ne_u32 vcc, s83, v108
    s_nop 0
    s_cmp_lg_u64 vcc, 0
    s_cbranch_scc1 L_xr_33
L_xb_34:
    s_nop 0
    v_pk_add_f32 v[128:129], v[128:129], v[96:97]
    v_pk_add_f32 v[130:131], v[130:131], v[98:99]
    v_pk_add_f32 v[132:133], v[132:133], v[100:101]
    v_pk_add_f32 v[134:135], v[134:135], v[102:103]
    v_cvt_pk_bf16_f32 v148, v128, v129
    v_cvt_pk_bf16_f32 v150, v132, v133
    v_cvt_pk_bf16_f32 v149, v130, v131
    v_cvt_pk_bf16_f32 v151, v134, v135
    s_add_u32 s82, s60, 6144
    v_permlane16_swap_b32 v148, v150
    v_permlane16_swap_b32 v149, v151
    v_or_b32 v148, 1, v148
    v_or_b32 v150, 1, v150
    buffer_store_dwordx4 v[148:151], v8, s[8:11], s82 offen sc1
    s_setprio 0
    s_branch L_ce_29
L_xr_33:
    s_mov_b32 s80, 0
L_xt_35:
    ds_read_b32 v108, v23 offset:37764
    ds_read_b128 v[96:99], v23 offset:2048
    ds_read_b128 v[100:103], v23 offset:3072
    s_waitcnt lgkmcnt(0)
    v_cmp_ne_u32 vcc, s83, v108
    s_nop 0
    s_cmp_eq_u64 vcc, 0
    s_cbranch_scc1 L_xb_34
    s_add_u32 s80, s80, 1
    s_cmp_lt_u32 s80, 1048576
    s_cbranch_scc1 L_xt_35
    s_branch L_end
L_cy_28:
    s_setprio 1
    s_cmp_lg_u32 s71, 0
    s_cbranch_scc1 L_a0_36
    ds_read_b128 v[64:67], v15 offset:2144
    ds_read_b128 v[68:71], v15 offset:2112
    ds_read_b128 v[80:83], v15 offset:2080
    ds_read_b128 v[84:87], v15 offset:2048
    ds_read_b128 v[96:99], v15 offset:2016
    ds_read_b128 v[100:103], v15 offset:1984
L_a0_36:
    ds_read_b128 v[72:75], v16 offset:4512
    ds_read_b128 v[76:79], v16 offset:2976
    ds_read_b128 v[88:91], v16 offset:4416
    ds_read_b128 v[92:95], v16 offset:2880
    ds_read_b128 v[104:107], v16 offset:4320
    ds_read_b128 v[108:111], v16 offset:2784
    s_cmp_eq_u32 s71, 0
    s_cbranch_scc1 L_pw_37
    s_add_u32 s83, s60, 2048
    v_mov_b32 v144, 0
    v_mov_b32 v145, 0
    v_mov_b32 v146, 0
    v_mov_b32 v147, 0
    buffer_store_dwordx4 v[144:147], v8, s[8:11], s83 offen sc1
    s_add_u32 s83, s60, 4096
    buffer_store_dwordx4 v[144:147], v8, s[8:11], s83 offen sc1
L_pw_37:
    s_waitcnt lgkmcnt(4)
    v_mfma_f32_16x16x32_bf16 v[128:131], v[64:67], v[72:75], 0
    ds_read_b128 v[112:115], v15 offset:1952
    v_mfma_f32_16x16x32_bf16 v[132:135], v[68:71], v[72:75], 0
    ds_read_b128 v[120:123], v16 offset:4224
    v_mfma_f32_16x16x32_bf16 v[136:139], v[64:67], v[76:79], 0
    ds_read_b128 v[116:119], v15 offset:1920
    v_mfma_f32_16x16x32_bf16 v[140:143], v[68:71], v[76:79], 0
    ds_read_b128 v[124:127], v16 offset:2688
    s_waitcnt lgkmcnt(6)
    v_mfma_f32_16x16x32_bf16 v[128:131], v[80:83], v[88:91], v[128:131]
    ds_read_b128 v[64:67], v15 offset:1888
    v_mfma_f32_16x16x32_bf16 v[132:135], v[84:87], v[88:91], v[132:135]
    ds_read_b128 v[72:75], v16 offset:4128
    v_mfma_f32_16x16x32_bf16 v[136:139], v[80:83], v[92:95], v[136:139]
    ds_read_b128 v[68:71], v15 offset:1856
    v_mfma_f32_16x16x32_bf16 v[140:143], v[84:87], v[92:95], v[140:143]
    ds_read_b128 v[76:79], v16 offset:2592
    s_waitcnt lgkmcnt(8)
    v_mfma_f32_16x16x32_bf16 v[128:131], v[96:99], v[104:107], v[128:131]
    ds_read_b128 v[80:83], v15 offset:1824
    v_mfma_f32_16x16x32_bf16 v[132:135], v[100:103], v[104:107], v[132:135]
    ds_read_b128 v[88:91], v16 offset:4032
    v_mfma_f32_16x16x32_bf16 v[136:139], v[96:99], v[108:111], v[136:139]
    ds_read_b128 v[84:87], v15 offset:1792
    v_mfma_f32_16x16x32_bf16 v[140:143], v[100:103], v[108:111], v[140:143]
    ds_read_b128 v[92:95], v16 offset:2496
    s_waitcnt lgkmcnt(8)
    v_mfma_f32_16x16x32_bf16 v[128:131], v[112:115], v[120:123], v[128:131]
    ds_read_b128 v[96:99], v15 offset:1760
    v_mfma_f32_16x16x32_bf16 v[132:135], v[116:119], v[120:123], v[132:135]
    ds_read_b128 v[104:107], v16 offset:3936
    v_mfma_f32_16x16x32_bf16 v[136:139], v[112:115], v[124:127], v[136:139]
    ds_read_b128 v[100:103], v15 offset:1728
    v_mfma_f32_16x16x32_bf16 v[140:143], v[116:119], v[124:127], v[140:143]
    ds_read_b128 v[108:111], v16 offset:2400
    s_waitcnt lgkmcnt(8)
    v_mfma_f32_16x16x32_bf16 v[128:131], v[64:67], v[72:75], v[128:131]
    ds_read_b128 v[112:115], v15 offset:1696
    v_mfma_f32_16x16x32_bf16 v[132:135], v[68:71], v[72:75], v[132:135]
    ds_read_b128 v[120:123], v16 offset:3840
    v_mfma_f32_16x16x32_bf16 v[136:139], v[64:67], v[76:79], v[136:139]
    ds_read_b128 v[116:119], v15 offset:1664
    v_mfma_f32_16x16x32_bf16 v[140:143], v[68:71], v[76:79], v[140:143]
    ds_read_b128 v[124:127], v16 offset:2304
    s_waitcnt lgkmcnt(8)
    v_mfma_f32_16x16x32_bf16 v[128:131], v[80:83], v[88:91], v[128:131]
    ds_read_b128 v[64:67], v15 offset:1632
    v_mfma_f32_16x16x32_bf16 v[132:135], v[84:87], v[88:91], v[132:135]
    ds_read_b128 v[72:75], v16 offset:3744
    v_mfma_f32_16x16x32_bf16 v[136:139], v[80:83], v[92:95], v[136:139]
    ds_read_b128 v[68:71], v15 offset:1600
    v_mfma_f32_16x16x32_bf16 v[140:143], v[84:87], v[92:95], v[140:143]
    ds_read_b128 v[76:79], v16 offset:2208
    s_waitcnt lgkmcnt(8)
    v_mfma_f32_16x16x32_bf16 v[128:131], v[96:99], v[104:107], v[128:131]
    ds_read_b128 v[80:83], v15 offset:1568
    v_mfma_f32_16x16x32_bf16 v[132:135], v[100:103], v[104:107], v[132:135]
    ds_read_b128 v[88:91], v16 offset:3648
    v_mfma_f32_16x16x32_bf16 v[136:139], v[96:99], v[108:111], v[136:139]
    ds_read_b128 v[84:87], v15 offset:1536
    v_mfma_f32_16x16x32_bf16 v[140:143], v[100:103], v[108:111], v[140:143]
    ds_read_b128 v[92:95], v16 offset:2112
    s_waitcnt lgkmcnt(8)
    v_mfma_f32_16x16x32_bf16 v[128:131], v[112:115], v[120:123], v[128:131]
    ds_read_b128 v[96:99], v15 offset:1504
    v_mfma_f32_16x16x32_bf16 v[132:135], v[116:119], v[120:123], v[132:135]
    ds_read_b128 v[104:107], v16 offset:3552
    v_mfma_f32_16x16x32_bf16 v[136:139], v[112:115], v[124:127], v[136:139]
    ds_read_b128 v[100:103], v15 offset:1472
    v_mfma_f32_16x16x32_bf16 v[140:143], v[116:119], v[124:127], v[140:143]
    ds_read_b128 v[108:111], v16 offset:2016
    s_waitcnt lgkmcnt(8)
    v_mfma_f32_16x16x32_bf16 v[128:131], v[64:67], v[72:75], v[128:131]
    ds_read_b128 v[112:115], v15 offset:1440
    v_mfma_f32_16x16x32_bf16 v[132:135], v[68:71], v[72:75], v[132:135]
    ds_read_b128 v[120:123], v16 offset:3456
    v_mfma_f32_16x16x32_bf16 v[136:139], v[64:67], v[76:79], v[136:139]
    ds_read_b128 v[116:119], v15 offset:1408
    v_mfma_f32_16x16x32_bf16 v[140:143], v[68:71], v[76:79], v[140:143]
    ds_read_b128 v[124:127], v16 offset:1920
    s_waitcnt lgkmcnt(8)
    v_mfma_f32_16x16x32_bf16 v[128:131], v[80:83], v[88:91], v[128:131]
    ds_read_b128 v[64:67], v15 offset:1376
    v_mfma_f32_16x16x32_bf16 v[132:135], v[84:87], v[88:91], v[132:135]
    ds_read_b128 v[72:75], v16 offset:3360
    v_mfma_f32_16x16x32_bf16 v[136:139], v[80:83], v[92:95], v[136:139]
    ds_read_b128 v[68:71], v15 offset:1344
    v_mfma_f32_16x16x32_bf16 v[140:143], v[84:87], v[92:95], v[140:143]
    ds_read_b128 v[76:79], v16 offset:1824
    s_waitcnt lgkmcnt(8)
    v_mfma_f32_16x16x32_bf16 v[128:131], v[96:99], v[104:107], v[128:131]
    ds_read_b128 v[80:83], v15 offset:1312
    v_mfma_f32_16x16x32_bf16 v[132:135], v[100:103], v[104:107], v[132:135]
    ds_read_b128 v[88:91], v16 offset:3264
    v_mfma_f32_16x16x32_bf16 v[136:139], v[96:99], v[108:111], v[136:139]
    ds_read_b128 v[84:87], v15 offset:1280
    v_mfma_f32_16x16x32_bf16 v[140:143], v[100:103], v[108:111], v[140:143]
    ds_read_b128 v[92:95], v16 offset:1728
    s_waitcnt lgkmcnt(8)
    v_mfma_f32_16x16x32_bf16 v[128:131], v[112:115], v[120:123], v[128:131]
    ds_read_b128 v[96:99], v15 offset:1248
    v_mfma_f32_16x16x32_bf16 v[132:135], v[116:119], v[120:123], v[132:135]
    ds_read_b128 v[104:107], v16 offset:3168
    v_mfma_f32_16x16x32_bf16 v[136:139], v[112:115], v[124:127], v[136:139]
    ds_read_b128 v[100:103], v15 offset:1216
    v_mfma_f32_16x16x32_bf16 v[140:143], v[116:119], v[124:127], v[140:143]
    ds_read_b128 v[108:111], v16 offset:1632
    s_waitcnt lgkmcnt(8)
    v_mfma_f32_16x16x32_bf16 v[128:131], v[64:67], v[72:75], v[128:131]
    ds_read_b128 v[112:115], v15 offset:1184
    v_mfma_f32_16x16x32_bf16 v[132:135], v[68:71], v[72:75], v[132:135]
    ds_read_b128 v[120:123], v16 offset:3072
    v_mfma_f32_16x16x32_bf16 v[136:139], v[64:67], v[76:79], v[136:139]
    ds_read_b128 v[116:119], v15 offset:1152
    v_mfma_f32_16x16x32_bf16 v[140:143], v[68:71], v[76:79], v[140:143]
    ds_read_b128 v[124:127], v16 offset:1536
    s_waitcnt lgkmcnt(8)
    v_mfma_f32_16x16x32_bf16 v[128:131], v[80:83], v[88:91], v[128:131]
    ds_read_b128 v[64:67], v15 offset:1120
    v_mfma_f32_16x16x32_bf16 v[132:135], v[84:87], v[88:91], v[132:135]
    ds_read_b128 v[72:75], v16 offset:2976
    v_mfma_f32_16x16x32_bf16 v[136:139], v[80:83], v[92:95], v[136:139]
    ds_read_b128 v[68:71], v15 offset:1088
    v_mfma_f32_16x16x32_bf16 v[140:143], v[84:87], v[92:95], v[140:143]
    ds_read_b128 v[76:79], v16 offset:1440
    s_waitcnt lgkmcnt(8)
    v_mfma_f32_16x16x32_bf16 v[128:131], v[96:99], v[104:107], v[128:131]
    ds_read_b128 v[80:83], v15 offset:1056
    v_mfma_f32_16x16x32_bf16 v[132:135], v[100:103], v[104:107], v[132:135]
    ds_read_b128 v[88:91], v16 offset:2880
    v_mfma_f32_16x16x32_bf16 v[136:139], v[96:99], v[108:111], v[136:139]
    ds_read_b128 v[84:87], v15 offset:1024
    v_mfma_f32_16x16x32_bf16 v[140:143], v[100:103], v[108:111], v[140:143]
    ds_read_b128 v[92:95], v16 offset:1344
    s_waitcnt lgkmcnt(8)
    v_mfma_f32_16x16x32_bf16 v[128:131], v[112:115], v[120:123], v[128:131]
    ds_read_b128 v[96:99], v15 offset:992
    v_mfma_f32_16x16x32_bf16 v[132:135], v[116:119], v[120:123], v[132:135]
    ds_read_b128 v[104:107], v16 offset:2784
    v_mfma_f32_16x16x32_bf16 v[136:139], v[112:115], v[124:127], v[136:139]
    ds_read_b128 v[100:103], v15 offset:960
    v_mfma_f32_16x16x32_bf16 v[140:143], v[116:119], v[124:127], v[140:143]
    ds_read_b128 v[108:111], v16 offset:1248
    s_waitcnt lgkmcnt(8)
    v_mfma_f32_16x16x32_bf16 v[128:131], v[64:67], v[72:75], v[128:131]
    ds_read_b128 v[112:115], v15 offset:928
    v_mfma_f32_16x16x32_bf16 v[132:135], v[68:71], v[72:75], v[132:135]
    ds_read_b128 v[120:123], v16 offset:2688
    v_mfma_f32_16x16x32_bf16 v[136:139], v[64:67], v[76:79], v[136:139]
    ds_read_b128 v[116:119], v15 offset:896
    v_mfma_f32_16x16x32_bf16 v[140:143], v[68:71], v[76:79], v[140:143]
    ds_read_b128 v[124:127], v16 offset:1152
    s_waitcnt lgkmcnt(8)
    v_mfma_f32_16x16x32_bf16 v[128:131], v[80:83], v[88:91], v[128:131]
    ds_read_b128 v[64:67], v15 offset:864
    v_mfma_f32_16x16x32_bf16 v[132:135], v[84:87], v[88:91], v[132:135]
    ds_read_b128 v[72:75], v16 offset:2592
    v_mfma_f32_16x16x32_bf16 v[136:139], v[80:83], v[92:95], v[136:139]
    ds_read_b128 v[68:71], v15 offset:832
    v_mfma_f32_16x16x32_bf16 v[140:143], v[84:87], v[92:95], v[140:143]
    ds_read_b128 v[76:79], v16 offset:1056
    s_waitcnt lgkmcnt(8)
    v_mfma_f32_16x16x32_bf16 v[128:131], v[96:99], v[104:107], v[128:131]
    ds_read_b128 v[80:83], v15 offset:800
    v_mfma_f32_16x16x32_bf16 v[132:135], v[100:103], v[104:107], v[132:135]
    ds_read_b128 v[88:91], v16 offset:2496
    v_mfma_f32_16x16x32_bf16 v[136:139], v[96:99], v[108:111], v[136:139]
    ds_read_b128 v[84:87], v15 offset:768
    v_mfma_f32_16x16x32_bf16 v[140:143], v[100:103], v[108:111], v[140:143]
    ds_read_b128 v[92:95], v16 offset:960
    s_waitcnt lgkmcnt(8)
    v_mfma_f32_16x16x32_bf16 v[128:131], v[112:115], v[120:123], v[128:131]
    ds_read_b128 v[96:99], v15 offset:736
    v_mfma_f32_16x16x32_bf16 v[132:135], v[116:119], v[120:123], v[132:135]
    ds_read_b128 v[104:107], v16 offset:2400
    v_mfma_f32_16x16x32_bf16 v[136:139], v[112:115], v[124:127], v[136:139]
    ds_read_b128 v[100:103], v15 offset:704
    v_mfma_f32_16x16x32_bf16 v[140:143], v[116:119], v[124:127], v[140:143]
    ds_read_b128 v[108:111], v16 offset:864
    s_waitcnt lgkmcnt(8)
    v_mfma_f32_16x16x32_bf16 v[128:131], v[64:67], v[72:75], v[128:131]
    ds_read_b128 v[112:115], v15 offset:672
    v_mfma_f32_16x16x32_bf16 v[132:135], v[68:71], v[72:75], v[132:135]
    ds_read_b128 v[120:123], v16 offset:2304
    v_mfma_f32_16x16x32_bf16 v[136:139], v[64:67], v[76:79], v[136:139]
    ds_read_b128 v[116:119], v15 offset:640
    v_mfma_f32_16x16x32_bf16 v[140:143], v[68:71], v[76:79], v[140:143]
    ds_read_b128 v[124:127], v16 offset:768
    s_waitcnt lgkmcnt(8)
    v_mfma_f32_16x16x32_bf16 v[128:131], v[80:83], v[88:91], v[128:131]
    ds_read_b128 v[64:67], v15 offset:608
    v_mfma_f32_16x16x32_bf16 v[132:135], v[84:87], v[88:91], v[132:135]
    ds_read_b128 v[72:75], v16 offset:2208
    v_mfma_f32_16x16x32_bf16 v[136:139], v[80:83], v[92:95], v[136:139]
    ds_read_b128 v[68:71], v15 offset:576
    v_mfma_f32_16x16x32_bf16 v[140:143], v[84:87], v[92:95], v[140:143]
    ds_read_b128 v[76:79], v16 offset:672
    s_waitcnt lgkmcnt(8)
    v_mfma_f32_16x16x32_bf16 v[128:131], v[96:99], v[104:107], v[128:131]
    ds_read_b128 v[80:83], v15 offset:544
    v_mfma_f32_16x16x32_bf16 v[132:135], v[100:103], v[104:107], v[132:135]
    ds_read_b128 v[88:91], v16 offset:2112
    v_mfma_f32_16x16x32_bf16 v[136:139], v[96:99], v[108:111], v[136:139]
    ds_read_b128 v[84:87], v15 offset:512
    v_mfma_f32_16x16x32_bf16 v[140:143], v[100:103], v[108:111], v[140:143]
    ds_read_b128 v[92:95], v16 offset:576
    s_waitcnt lgkmcnt(8)
    v_mfma_f32_16x16x32_bf16 v[128:131], v[112:115], v[120:123], v[128:131]
    ds_read_b128 v[96:99], v15 offset:480
    v_mfma_f32_16x16x32_bf16 v[132:135], v[116:119], v[120:123], v[132:135]
    ds_read_b128 v[104:107], v16 offset:2016
    v_mfma_f32_16x16x32_bf16 v[136:139], v[112:115], v[124:127], v[136:139]
    ds_read_b128 v[100:103], v15 offset:448
    v_mfma_f32_16x16x32_bf16 v[140:143], v[116:119], v[124:127], v[140:143]
    ds_read_b128 v[108:111], v16 offset:480
    s_waitcnt lgkmcnt(8)
    v_mfma_f32_16x16x32_bf16 v[128:131], v[64:67], v[72:75], v[128:131]
    ds_read_b128 v[112:115], v15 offset:416
    v_mfma_f32_16x16x32_bf16 v[132:135], v[68:71], v[72:75], v[132:135]
    ds_read_b128 v[120:123], v16 offset:1920
    v_mfma_f32_16x16x32_bf16 v[136:139], v[64:67], v[76:79], v[136:139]
    ds_read_b128 v[116:119], v15 offset:384
    v_mfma_f32_16x16x32_bf16 v[140:143], v[68:71], v[76:79], v[140:143]
    ds_read_b128 v[124:127], v16 offset:384
    s_waitcnt lgkmcnt(8)
    v_mfma_f32_16x16x32_bf16 v[128:131], v[80:83], v[88:91], v[128:131]
    ds_read_b128 v[64:67], v15 offset:352
    v_mfma_f32_16x16x32_bf16 v[132:135], v[84:87], v[88:91], v[132:135]
    ds_read_b128 v[72:75], v16 offset:1824
    v_mfma_f32_16x16x32_bf16 v[136:139], v[80:83], v[92:95], v[136:139]
    ds_read_b128 v[68:71], v15 offset:320
    v_mfma_f32_16x16x32_bf16 v[140:143], v[84:87], v[92:95], v[140:143]
    ds_read_b128 v[76:79], v16 offset:288
    s_waitcnt lgkmcnt(8)
    v_mfma_f32_16x16x32_bf16 v[128:131], v[96:99], v[104:107], v[128:131]
    ds_read_b128 v[80:83], v15 offset:288
    v_mfma_f32_16x16x32_bf16 v[132:135], v[100:103], v[104:107], v[132:135]
    ds_read_b128 v[88:91], v16 offset:1728
    v_mfma_f32_16x16x32_bf16 v[136:139], v[96:99], v[108:111], v[136:139]
    ds_read_b128 v[84:87], v15 offset:256
    v_mfma_f32_16x16x32_bf16 v[140:143], v[100:103], v[108:111], v[140:143]
    ds_read_b128 v[92:95], v16 offset:192
    s_waitcnt lgkmcnt(8)
    v_mfma_f32_16x16x32_bf16 v[128:131], v[112:115], v[120:123], v[128:131]
    ds_read_b128 v[96:99], v15 offset:224
    v_mfma_f32_16x16x32_bf16 v[132:135], v[116:119], v[120:123], v[132:135]
    ds_read_b128 v[104:107], v16 offset:1632
    v_mfma_f32_16x16x32_bf16 v[136:139], v[112:115], v[124:127], v[136:139]
    ds_read_b128 v[100:103], v15 offset:192
    v_mfma_f32_16x16x32_bf16 v[140:143], v[116:119], v[124:127], v[140:143]
    ds_read_b128 v[108:111], v16 offset:96
    s_waitcnt lgkmcnt(8)
    v_mfma_f32_16x16x32_bf16 v[128:131], v[64:67], v[72:75], v[128:131]
    ds_read_b128 v[112:115], v15 offset:160
    v_mfma_f32_16x16x32_bf16 v[132:135], v[68:71], v[72:75], v[132:135]
    ds_read_b128 v[120:123], v16 offset:1536
    v_mfma_f32_16x16x32_bf16 v[136:139], v[64:67], v[76:79], v[136:139]
    ds_read_b128 v[116:119], v15 offset:128
    v_mfma_f32_16x16x32_bf16 v[140:143], v[68:71], v[76:79], v[140:143]
    ds_read_b128 v[124:127], v16 offset:0
    s_waitcnt lgkmcnt(8)
    v_mfma_f32_16x16x32_bf16 v[128:131], v[80:83], v[88:91], v[128:131]
    v_mfma_f32_16x16x32_bf16 v[132:135], v[84:87], v[88:91], v[132:135]
    ds_read_b128 v[64:67], v15 offset:96
    v_mfma_f32_16x16x32_bf16 v[136:139], v[80:83], v[92:95], v[136:139]
    ds_read_b128 v[72:75], v16 offset:1440
    v_mfma_f32_16x16x32_bf16 v[140:143], v[84:87], v[92:95], v[140:143]
    ds_read_b128 v[68:71], v15 offset:64
    s_waitcnt lgkmcnt(7)
    v_mfma_f32_16x16x32_bf16 v[128:131], v[96:99], v[104:107], v[128:131]
    v_mfma_f32_16x16x32_bf16 v[132:135], v[100:103], v[104:107], v[132:135]
    ds_read_b128 v[80:83], v15 offset:32
    v_mfma_f32_16x16x32_bf16 v[136:139], v[96:99], v[108:111], v[136:139]
    ds_read_b128 v[88:91], v16 offset:1344
    v_mfma_f32_16x16x32_bf16 v[140:143], v[100:103], v[108:111], v[140:143]
    ds_read_b128 v[84:87], v15 offset:0
    s_waitcnt lgkmcnt(6)
    v_mfma_f32_16x16x32_bf16 v[128:131], v[112:115], v[120:123], v[128:131]
    v_mfma_f32_16x16x32_bf16 v[132:135], v[116:119], v[120:123], v[132:135]
    ds_read_b32 v108, v23 offset:37760
    v_mfma_f32_16x16x32_bf16 v[136:139], v[112:115], v[124:127], v[136:139]
    ds_read_b128 v[96:99], v23 offset:0
    v_mfma_f32_16x16x32_bf16 v[140:143], v[116:119], v[124:127], v[140:143]
    ds_read_b128 v[100:103], v23 offset:1024
    s_waitcnt lgkmcnt(6)
    v_mfma_f32_16x16x32_bf16 v[128:131], v[64:67], v[72:75], v[128:131]
    v_mfma_f32_16x16x32_bf16 v[132:135], v[68:71], v[72:75], v[132:135]
    s_waitcnt lgkmcnt(3)
    v_mfma_f32_16x16x32_bf16 v[128:131], v[80:83], v[88:91], v[128:131]
    v_mfma_f32_16x16x32_bf16 v[132:135], v[84:87], v[88:91], v[132:135]
    v_cvt_pk_bf16_f32 v144, v136, v137
    v_cvt_pk_bf16_f32 v146, v140, v141
    v_cvt_pk_bf16_f32 v145, v138, v139
    v_cvt_pk_bf16_f32 v147, v142, v143
    s_add_u32 s82, s60, 2048
    v_permlane16_swap_b32 v144, v146
    v_permlane16_swap_b32 v145, v147
    v_or_b32 v144, 1, v144
    v_or_b32 v146, 1, v146
    buffer_store_dwordx4 v[144:147], v8, s[8:11], s82 offen sc1
    s_add_u32 s83, s71, 1
    s_waitcnt lgkmcnt(0)
    v_cmp_ne_u32 vcc, s83, v108
    s_nop 0
    s_cmp_lg_u64 vcc, 0
    s_cbranch_scc1 L_xr_38
L_xb_39:
    v_pk_add_f32 v[128:129], v[128:129], v[96:97]
    v_pk_add_f32 v[130:131], v[130:131], v[98:99]
    v_pk_add_f32 v[132:133], v[132:133], v[100:101]
    v_pk_add_f32 v[134:135], v[134:135], v[102:103]
    v_cvt_pk_bf16_f32 v148, v128, v129
    v_cvt_pk_bf16_f32 v150, v132, v133
    v_cvt_pk_bf16_f32 v149, v130, v131
    v_cvt_pk_bf16_f32 v151, v134, v135
    s_add_u32 s82, s60, 4096
    v_permlane16_swap_b32 v148, v150
    v_permlane16_swap_b32 v149, v151
    v_or_b32 v148, 1, v148
    v_or_b32 v150, 1, v150
    buffer_store_dwordx4 v[148:151], v8, s[8:11], s82 offen sc1
    s_setprio 0
    s_branch L_ce_29
L_xr_38:
    s_mov_b32 s80, 0
L_xt_40:
    ds_read_b32 v108, v23 offset:37760
    ds_read_b128 v[96:99], v23 offset:0
    ds_read_b128 v[100:103], v23 offset:1024
    s_waitcnt lgkmcnt(0)
    v_cmp_ne_u32 vcc, s83, v108
    s_nop 0
    s_cmp_eq_u64 vcc, 0
    s_cbranch_scc1 L_xb_39
    s_add_u32 s80, s80, 1
    s_cmp_lt_u32 s80, 1048576
    s_cbranch_scc1 L_xt_40
    s_branch L_end
L_ci_30:
    s_sub_u32 s82, s4, 5
    s_cmp_lt_u32 s82, 2
    s_cbranch_scc1 L_nf_41
    s_setprio 2
    s_and_b32 s82, s4, 1
    s_mul_i32 s83, s82, 7584
    s_add_u32 s83, s83, 74080
    v_lshlrev_b32 v136, 4, v1
    v_add_u32 v136, 149216, v136
    ds_read_b128 v[128:131], v136
    ds_read_b128 v[132:135], v136 offset:1024
    v_lshlrev_b32 v136, 4, v2
    v_lshl_add_u32 v136, v3, 3, v136
    v_add_u32 v137, 16, v136
    v_add_u32 v136, 8, v136
    v_lshrrev_b32 v138, 5, v136
    v_and_b32 v136, 31, v136
    v_mul_u32_u24 v138, 96, v138
    v_lshl_add_u32 v136, v136, 1, v138
    v_add_u32 v136, s83, v136
    v_lshrrev_b32 v138, 5, v137
    v_and_b32 v137, 31, v137
    v_mul_u32_u24 v138, 96, v138
    v_lshl_add_u32 v137, v137, 1, v138
    v_add_u32 v137, s83, v137
    ds_read_b128 v[64:67], v136 offset:0
    ds_read_b128 v[68:71], v136 offset:768
    ds_read_b128 v[72:75], v136 offset:1536
    ds_read_b128 v[76:79], v136 offset:2304
    ds_read_b128 v[80:83], v137 offset:0
    ds_read_b128 v[84:87], v137 offset:768
    ds_read_b128 v[88:91], v137 offset:1536
    ds_read_b128 v[92:95], v137 offset:2304
    s_lshl_b32 s83, s82, 13
    s_add_u32 s83, s83, 43264
    v_lshl_add_u32 v138, v1, 4, s83
    s_lshl_b32 s83, s82, 12
    s_add_u32 s83, s83, 87904
    v_lshl_add_u32 v139, v1, 4, s83
    s_add_u32 s83, s71, 1
    v_mov_b32 v140, s83
    v_mov_b32 v141, s83
    s_waitcnt lgkmcnt(7)
    v_mfma_f32_16x16x32_bf16 v[96:99], v[64:67], v[128:131], 0
    s_waitcnt lgkmcnt(6)
    v_mfma_f32_16x16x32_bf16 v[100:103], v[68:71], v[128:131], 0
    s_waitcnt lgkmcnt(5)
    v_mfma_f32_16x16x32_bf16 v[104:107], v[72:75], v[128:131], 0
    s_waitcnt lgkmcnt(4)
    v_mfma_f32_16x16x32_bf16 v[108:111], v[76:79], v[128:131], 0
    s_waitcnt lgkmcnt(3)
    v_mfma_f32_16x16x32_bf16 v[112:115], v[80:83], v[132:135], 0
    s_waitcnt lgkmcnt(2)
    v_mfma_f32_16x16x32_bf16 v[116:119], v[84:87], v[132:135], 0
    s_waitcnt lgkmcnt(1)
    v_mfma_f32_16x16x32_bf16 v[120:123], v[88:91], v[132:135], 0
    s_waitcnt lgkmcnt(0)
    v_mfma_f32_16x16x32_bf16 v[124:127], v[92:95], v[132:135], 0
    v_cvt_pk_bf16_f32 v64, v96, v97
    v_cvt_pk_bf16_f32 v65, v98, v99
    v_cvt_pk_bf16_f32 v66, v100, v101
    v_cvt_pk_bf16_f32 v67, v102, v103
    v_cvt_pk_bf16_f32 v68, v104, v105
    v_cvt_pk_bf16_f32 v69, v106, v107
    v_cvt_pk_bf16_f32 v70, v108, v109
    v_cvt_pk_bf16_f32 v71, v110, v111
    v_cvt_pk_bf16_f32 v72, v112, v113
    v_cvt_pk_bf16_f32 v73, v114, v115
    v_cvt_pk_bf16_f32 v74, v116, v117
    v_cvt_pk_bf16_f32 v75, v118, v119
    v_cvt_pk_bf16_f32 v76, v120, v121
    v_cvt_pk_bf16_f32 v77, v122, v123
    v_cvt_pk_bf16_f32 v78, v124, v125
    v_cvt_pk_bf16_f32 v79, v126, v127
    ds_read_b128 v[96:99], v138 offset:0
    ds_read_b128 v[100:103], v138 offset:1024
    ds_read_b128 v[104:107], v138 offset:2048
    ds_read_b128 v[108:111], v138 offset:3072
    ds_read_b128 v[112:115], v138 offset:4096
    ds_read_b128 v[116:119], v138 offset:5120
    ds_read_b128 v[120:123], v138 offset:6144
    ds_read_b128 v[124:127], v138 offset:7168
    s_waitcnt lgkmcnt(4)
    v_mfma_f32_16x16x32_bf16 v[80:83], v[64:67], v[96:99], 0
    v_mfma_f32_16x16x32_bf16 v[88:91], v[64:67], v[100:103], 0
    v_mfma_f32_16x16x32_bf16 v[88:91], v[68:71], v[96:99], v[88:91]
    v_mfma_f32_16x16x32_bf16 v[84:87], v[64:67], v[104:107], 0
    v_mfma_f32_16x16x32_bf16 v[92:95], v[64:67], v[108:111], 0
    v_mfma_f32_16x16x32_bf16 v[92:95], v[68:71], v[104:107], v[92:95]
    s_waitcnt lgkmcnt(0)
    v_mfma_f32_16x16x32_bf16 v[80:83], v[72:75], v[112:115], v[80:83]
    v_mfma_f32_16x16x32_bf16 v[88:91], v[72:75], v[116:119], v[88:91]
    v_mfma_f32_16x16x32_bf16 v[88:91], v[76:79], v[112:115], v[88:91]
    v_mfma_f32_16x16x32_bf16 v[84:87], v[72:75], v[120:123], v[84:87]
    v_mfma_f32_16x16x32_bf16 v[92:95], v[72:75], v[124:127], v[92:95]
    v_mfma_f32_16x16x32_bf16 v[92:95], v[76:79], v[120:123], v[92:95]
    s_nop 2
    ds_write_b128 v139, v[80:83] offset:0
    s_nop 1
    ds_write_b128 v139, v[84:87] offset:1024
    ds_write_b128 v139, v[88:91] offset:2048
    ds_write_b128 v139, v[92:95] offset:3072
    ds_write_b64 v139, v[140:141] offset:37760
    s_setprio 0
L_nf_41:
    s_cmp_lg_u32 s71, 0
    s_cbranch_scc1 L_fl_42
    v_lshlrev_b32 v84, 4, v0
    s_lshl_b32 s82, s3, 13
    s_sub_u32 s82, s82, 4096
    v_add_u32 v85, s82, v84
    v_add_u32 v84, 100448, v84
    ds_read_b128 v[68:71], v84
    ds_read_b128 v[72:75], v84 offset:4096
    v_add_u32 v86, 0x1000, v85
    s_waitcnt lgkmcnt(0)
    buffer_store_dwordx4 v[68:71], v85, s[12:15], 0 offen sc1
    buffer_store_dwordx4 v[72:75], v86, s[12:15], 0 offen sc1
    v_lshlrev_b32 v88, 4, v1
    v_add_u32 v88, 130784, v88
    ds_read_b128 a[0:3], v88 offset:0
    ds_read_b128 a[4:7], v88 offset:1024
    ds_read_b128 a[8:11], v88 offset:2048
    ds_read_b128 a[12:15], v88 offset:3072
    ds_read_b128 a[16:19], v88 offset:4096
    ds_read_b128 a[20:23], v88 offset:5120
    ds_read_b128 a[24:27], v88 offset:6144
    ds_read_b128 a[28:31], v88 offset:7168
    ds_read_b128 a[32:35], v88 offset:8192
    ds_read_b128 a[36:39], v88 offset:9216
    ds_read_b128 a[40:43], v88 offset:10240
    ds_read_b128 a[44:47], v88 offset:11264
    s_waitcnt lgkmcnt(4)
    ds_read_b128 a[48:51], v88 offset:12288
    ds_read_b128 a[52:55], v88 offset:13312
    ds_read_b128 a[56:59], v88 offset:14336
    ds_read_b128 a[60:63], v88 offset:15360
    ds_read_b128 v[40:43], v88 offset:16384
    ds_read_b128 v[44:47], v88 offset:17408
    v_lshrrev_b32 v92, 1, v0
    v_and_b32 v93, 1, v0
    v_mul_u32_u24 v89, 8320, v92
    s_lshr_b32 s83, s3, 2
    s_lshl_b32 s83, s83, 7
    s_and_b32 s84, s3, 3
    s_lshl_b32 s84, s84, 4
    s_add_u32 s83, s83, s84
    v_lshl_add_u32 v6, v93, 6, v89
    v_add_u32 v6, s83, v6
    v_mul_u32_u24 v13, 4160, v93
    v_lshl_add_u32 v13, v92, 2, v13
    v_add_u32 v13, 87904, v13
    v_lshrrev_b32 v90, 1, v3
    v_and_b32 v91, 1, v3
    s_lshl_b32 s84, s4, 2
    s_lshl_b32 s82, s3, 5
    v_lshrrev_b32 v10, 2, v2
    v_lshl_add_u32 v10, v10, 1, v90
    v_lshlrev_b32 v10, 5, v10
    v_and_b32 v90, 3, v2
    v_add3_u32 v10, v10, v90, s84
    v_lshlrev_b32 v10, 13, v10
    v_lshl_add_u32 v10, v91, 4, v10
    v_add_u32 v10, s82, v10
    s_mov_b32 s76, 0x00010001
    s_mov_b32 s77, 0x00010001
    s_mov_b32 s78, 0xffff
    s_mov_b32 s79, 0
    s_mov_b32 s86, 0x3f80
    s_mov_b32 s87, 0x3f800000
    v_lshrrev_b32 v84, 1, v3
    v_and_b32 v85, 1, v3
    v_lshrrev_b32 v86, 3, v2
    v_and_b32 v87, 7, v2
    v_lshlrev_b32 v7, 7, v85
    v_lshl_add_u32 v7, v84, 1, v7
    v_add_u32 v7, v7, v86
    s_lshl_b32 s83, s4, 2
    s_lshl_b32 s82, s3, 5
    v_add_u32 v7, s83, v7
    v_mul_u32_u24 v7, 8320, v7
    v_lshl_add_u32 v7, v87, 2, v7
    v_add_u32 v7, s82, v7
    s_mov_b32 s64, 0
    s_mov_b32 s65, 266240
    s_mov_b32 s66, 532480
    s_mov_b32 s67, 798720
    s_lshl_b32 s84, s4, 7
    s_add_u32 s84, s84, s6
    v_lshlrev_b32 v9, 10, v87
    v_lshl_add_u32 v9, v86, 6, v9
    v_lshl_add_u32 v9, v3, 4, v9
    v_add_u32 v9, s84, v9
    v_lshlrev_b32 v22, 9, v85
    v_lshl_add_u32 v22, v2, 5, v22
    v_lshl_add_u32 v22, v84, 4, v22
    s_mov_b32 s85, 80
    s_mul_i32 s84, s4, 160
    v_mul_u32_u24 v17, 1296, v87
    v_mad_u32_u24 v17, v86, s85, v17
    v_lshl_add_u32 v17, v3, 4, v17
    s_add_u32 s83, s84, 104544
    v_add_u32 v17, s83, v17
    s_mul_i32 s83, s4, 1296
    s_add_u32 s83, s83, 104544
    v_mul_u32_u24 v18, 320, v3
    v_lshl_add_u32 v18, v2, 2, v18
    v_add_u32 v18, s83, v18
    s_mul_i32 s83, s4, 1344
    s_add_u32 s83, s83, 114912
    v_mul_u32_u24 v19, 80, v2
    v_lshl_add_u32 v19, v3, 4, v19
    v_add_u32 v19, s83, v19
    s_add_u32 s83, s84, 114912
    v_mul_u32_u24 v20, 5376, v85
    v_mad_u32_u24 v20, v84, s85, v20
    v_lshl_add_u32 v20, v2, 2, v20
    v_add_u32 v20, s83, v20
    s_waitcnt lgkmcnt(0)
    v_pk_fma_f32 v[24:25], v[48:49], v[152:153], v[24:25]
    v_pk_fma_f32 v[26:27], v[50:51], v[154:155], v[26:27]
    v_pk_fma_f32 v[28:29], v[52:53], v[156:157], v[28:29]
    v_pk_fma_f32 v[30:31], v[54:55], v[158:159], v[30:31]
    v_lshl_add_u32 v84, v2, 3, s4
    v_lshlrev_b32 v85, 2, v3
    v_add_u32 v86, 0, v85
    v_mul_u32_u24 v86, v86, v84
    v_cvt_f32_u32 v87, v86
    v_mul_f32 v88, 0x3c000000, v87
    v_mul_f32 v87, 0x3a000000, v87
    v_cos_f32 v89, v88
    v_sin_f32 v90, v88
    v_cos_f32 v48, v87
    v_sin_f32 v52, v87
    v_cvt_pk_bf16_f32 v86, v89, v90
    v_cvt_pk_bf16_f32 v88, -v90, v89
    v_accvgpr_write_b32 a64, v86
    v_accvgpr_write_b32 a68, v88
    v_add_u32 v91, 0, v85
    v_lshl_add_u32 v91, v91, 3, s4
    v_mul_u32_u24 v91, v91, v2
    v_cvt_f32_u32 v92, v91
    v_mul_f32 v93, 0x3c000000, v92
    v_mul_f32 v92, 0x3a000000, v92
    v_cos_f32 v94, v93
    v_sin_f32 v95, v93
    v_cos_f32 v56, v92
    v_sin_f32 v60, v92
    v_cvt_pk_bf16_f32 v91, v94, v95
    v_cvt_pk_bf16_f32 v93, -v95, v94
    v_accvgpr_write_b32 a72, v91
    v_accvgpr_write_b32 a76, v93
    v_add_u32 v86, 1, v85
    v_mul_u32_u24 v86, v86, v84
    v_cvt_f32_u32 v87, v86
    v_mul_f32 v88, 0x3c000000, v87
    v_mul_f32 v87, 0x3a000000, v87
    v_cos_f32 v89, v88
    v_sin_f32 v90, v88
    v_cos_f32 v49, v87
    v_sin_f32 v53, v87
    v_cvt_pk_bf16_f32 v86, v89, v90
    v_cvt_pk_bf16_f32 v88, -v90, v89
    v_accvgpr_write_b32 a65, v86
    v_accvgpr_write_b32 a69, v88
    v_add_u32 v91, 1, v85
    v_lshl_add_u32 v91, v91, 3, s4
    v_mul_u32_u24 v91, v91, v2
    v_cvt_f32_u32 v92, v91
    v_mul_f32 v93, 0x3c000000, v92
    v_mul_f32 v92, 0x3a000000, v92
    v_cos_f32 v94, v93
    v_sin_f32 v95, v93
    v_cos_f32 v57, v92
    v_sin_f32 v61, v92
    v_cvt_pk_bf16_f32 v91, v94, v95
    v_cvt_pk_bf16_f32 v93, -v95, v94
    v_accvgpr_write_b32 a73, v91
    v_accvgpr_write_b32 a77, v93
    v_add_u32 v86, 2, v85
    v_mul_u32_u24 v86, v86, v84
    v_cvt_f32_u32 v87, v86
    v_mul_f32 v88, 0x3c000000, v87
    v_mul_f32 v87, 0x3a000000, v87
    v_cos_f32 v89, v88
    v_sin_f32 v90, v88
    v_cos_f32 v50, v87
    v_sin_f32 v54, v87
    v_cvt_pk_bf16_f32 v86, v89, v90
    v_cvt_pk_bf16_f32 v88, -v90, v89
    v_accvgpr_write_b32 a66, v86
    v_accvgpr_write_b32 a70, v88
    v_add_u32 v91, 2, v85
    v_lshl_add_u32 v91, v91, 3, s4
    v_mul_u32_u24 v91, v91, v2
    v_cvt_f32_u32 v92, v91
    v_mul_f32 v93, 0x3c000000, v92
    v_mul_f32 v92, 0x3a000000, v92
    v_cos_f32 v94, v93
    v_sin_f32 v95, v93
    v_cos_f32 v58, v92
    v_sin_f32 v62, v92
    v_cvt_pk_bf16_f32 v91, v94, v95
    v_cvt_pk_bf16_f32 v93, -v95, v94
    v_accvgpr_write_b32 a74, v91
    v_accvgpr_write_b32 a78, v93
    v_add_u32 v86, 3, v85
    v_mul_u32_u24 v86, v86, v84
    v_cvt_f32_u32 v87, v86
    v_mul_f32 v88, 0x3c000000, v87
    v_mul_f32 v87, 0x3a000000, v87
    v_cos_f32 v89, v88
    v_sin_f32 v90, v88
    v_cos_f32 v51, v87
    v_sin_f32 v55, v87
    v_cvt_pk_bf16_f32 v86, v89, v90
    v_cvt_pk_bf16_f32 v88, -v90, v89
    v_accvgpr_write_b32 a67, v86
    v_accvgpr_write_b32 a71, v88
    v_add_u32 v91, 3, v85
    v_lshl_add_u32 v91, v91, 3, s4
    v_mul_u32_u24 v91, v91, v2
    v_cvt_f32_u32 v92, v91
    v_mul_f32 v93, 0x3c000000, v92
    v_mul_f32 v92, 0x3a000000, v92
    v_cos_f32 v94, v93
    v_sin_f32 v95, v93
    v_cos_f32 v59, v92
    v_sin_f32 v63, v92
    v_cvt_pk_bf16_f32 v91, v94, v95
    v_cvt_pk_bf16_f32 v93, -v95, v94
    v_accvgpr_write_b32 a75, v91
    v_accvgpr_write_b32 a79, v93
L_fl_42:
    s_branch L_cd_43
L_ce_29:
    s_cmp_lg_u32 s71, 0
    s_cbranch_scc1 L_fl_44
    v_lshlrev_b32 v88, 4, v1
    v_add_u32 v88, 130784, v88
    ds_read_b128 a[0:3], v88 offset:0
    ds_read_b128 a[4:7], v88 offset:1024
    ds_read_b128 a[8:11], v88 offset:2048
    ds_read_b128 a[12:15], v88 offset:3072
    ds_read_b128 a[16:19], v88 offset:4096
    ds_read_b128 a[20:23], v88 offset:5120
    ds_read_b128 a[24:27], v88 offset:6144
    ds_read_b128 a[28:31], v88 offset:7168
    ds_read_b128 a[32:35], v88 offset:8192
    ds_read_b128 a[36:39], v88 offset:9216
    ds_read_b128 a[40:43], v88 offset:10240
    ds_read_b128 a[44:47], v88 offset:11264
    s_waitcnt lgkmcnt(4)
    ds_read_b128 a[48:51], v88 offset:12288
    ds_read_b128 a[52:55], v88 offset:13312
    ds_read_b128 a[56:59], v88 offset:14336
    ds_read_b128 a[60:63], v88 offset:15360
    ds_read_b128 v[40:43], v88 offset:16384
    ds_read_b128 v[44:47], v88 offset:17408
    v_lshrrev_b32 v92, 1, v0
    v_and_b32 v93, 1, v0
    v_mul_u32_u24 v89, 8320, v92
    s_lshr_b32 s83, s3, 2
    s_lshl_b32 s83, s83, 7
    s_and_b32 s84, s3, 3
    s_lshl_b32 s84, s84, 4
    s_add_u32 s83, s83, s84
    v_lshl_add_u32 v6, v93, 6, v89
    v_add_u32 v6, s83, v6
    v_mul_u32_u24 v13, 4160, v93
    v_lshl_add_u32 v13, v92, 2, v13
    v_add_u32 v13, 87904, v13
    v_lshrrev_b32 v90, 1, v3
    v_and_b32 v91, 1, v3
    s_lshl_b32 s84, s4, 2
    s_lshl_b32 s82, s3, 5
    v_lshrrev_b32 v10, 2, v2
    v_lshl_add_u32 v10, v10, 1, v90
    v_lshlrev_b32 v10, 5, v10
    v_and_b32 v90, 3, v2
    v_add3_u32 v10, v10, v90, s84
    v_lshlrev_b32 v10, 13, v10
    v_lshl_add_u32 v10, v91, 4, v10
    v_add_u32 v10, s82, v10
    s_mov_b32 s76, 0x00010001
    s_mov_b32 s77, 0x00010001
    s_mov_b32 s78, 0xffff
    s_mov_b32 s79, 0
    s_mov_b32 s86, 0x3f80
    s_mov_b32 s87, 0x3f800000
    v_lshrrev_b32 v84, 1, v3
    v_and_b32 v85, 1, v3
    v_lshrrev_b32 v86, 3, v2
    v_and_b32 v87, 7, v2
    v_lshlrev_b32 v7, 7, v85
    v_lshl_add_u32 v7, v84, 1, v7
    v_add_u32 v7, v7, v86
    s_lshl_b32 s83, s4, 2
    s_lshl_b32 s82, s3, 5
    v_add_u32 v7, s83, v7
    v_mul_u32_u24 v7, 8320, v7
    v_lshl_add_u32 v7, v87, 2, v7
    v_add_u32 v7, s82, v7
    s_mov_b32 s64, 0
    s_mov_b32 s65, 266240
    s_mov_b32 s66, 532480
    s_mov_b32 s67, 798720
    s_lshl_b32 s84, s4, 7
    s_add_u32 s84, s84, s6
    v_lshlrev_b32 v9, 10, v87
    v_lshl_add_u32 v9, v86, 6, v9
    v_lshl_add_u32 v9, v3, 4, v9
    v_add_u32 v9, s84, v9
    v_lshlrev_b32 v22, 9, v85
    v_lshl_add_u32 v22, v2, 5, v22
    v_lshl_add_u32 v22, v84, 4, v22
    s_mov_b32 s85, 80
    s_mul_i32 s84, s4, 160
    v_mul_u32_u24 v17, 1296, v87
    v_mad_u32_u24 v17, v86, s85, v17
    v_lshl_add_u32 v17, v3, 4, v17
    s_add_u32 s83, s84, 104544
    v_add_u32 v17, s83, v17
    s_mul_i32 s83, s4, 1296
    s_add_u32 s83, s83, 104544
    v_mul_u32_u24 v18, 320, v3
    v_lshl_add_u32 v18, v2, 2, v18
    v_add_u32 v18, s83, v18
    s_mul_i32 s83, s4, 1344
    s_add_u32 s83, s83, 114912
    v_mul_u32_u24 v19, 80, v2
    v_lshl_add_u32 v19, v3, 4, v19
    v_add_u32 v19, s83, v19
    s_add_u32 s83, s84, 114912
    v_mul_u32_u24 v20, 5376, v85
    v_mad_u32_u24 v20, v84, s85, v20
    v_lshl_add_u32 v20, v2, 2, v20
    v_add_u32 v20, s83, v20
    s_waitcnt lgkmcnt(0)
    v_pk_fma_f32 v[24:25], v[48:49], v[152:153], v[24:25]
    v_pk_fma_f32 v[26:27], v[50:51], v[154:155], v[26:27]
    v_pk_fma_f32 v[28:29], v[52:53], v[156:157], v[28:29]
    v_pk_fma_f32 v[30:31], v[54:55], v[158:159], v[30:31]
L_fl_44:
L_cd_43:
    s_waitcnt vmcnt(0) lgkmcnt(0)
    s_barrier
    s_mov_b32 s80, 0
L_poll_y_45:
    buffer_load_dwordx4 v[64:67], v6, s[8:11], s60 offen sc1
    s_waitcnt vmcnt(0)
    v_bitop3_b32 v151, v64, v66, 1 bitop3:0x2a
    v_cmp_ne_u32 vcc, 0, v151
    s_nop 0
    s_and_b64 exec, exec, vcc
    s_cbranch_scc0 L_done_y_46
    s_add_u32 s80, s80, 1
    s_cmp_lt_u32 s80, 1048576
    s_cbranch_scc1 L_poll_y_45
    s_mov_b64 exec, -1
    s_branch L_end
L_done_y_46:
    s_mov_b64 exec, -1
    ds_write_b16 v11, v64 offset:0
    ds_write_b16_d16_hi v11, v64 offset:1040
    ds_write_b16 v11, v65 offset:2080
    ds_write_b16_d16_hi v11, v65 offset:3120
    ds_write_b16 v11, v66 offset:4160
    ds_write_b16_d16_hi v11, v66 offset:5200
    ds_write_b16 v11, v67 offset:6240
    ds_write_b16_d16_hi v11, v67 offset:7280
    s_waitcnt lgkmcnt(0)
    s_barrier
    ds_read_b128 v[68:71], v12
    s_cmp_lg_u32 s71, 0
    s_cbranch_scc1 L_fl_47
L_fl_47:
    v_mov_b32 v100, 1
    v_mov_b32 v101, 1
    v_mov_b32 v102, 1
    v_mov_b32 v103, 1
    buffer_store_dwordx4 v[100:103], v4, s[8:11], 0 offen sc1
    s_cmp_lt_u32 s4, 4
    s_cbranch_scc1 L_yp_48
    s_setprio 1
L_yp_48:
    s_waitcnt lgkmcnt(0)
    v_dot2c_f32_bf16 v24, s86, v68
    v_dot2c_f32_bf16 v25, s87, v68
    v_dot2c_f32_bf16 v26, s86, v69
    v_dot2c_f32_bf16 v27, s87, v69
    v_dot2c_f32_bf16 v28, s86, v70
    v_dot2c_f32_bf16 v29, s87, v70
    v_dot2c_f32_bf16 v30, s86, v71
    v_dot2c_f32_bf16 v31, s87, v71
    v_pk_mul_f32 v[82:83], v[24:25], v[24:25]
    v_pk_add_f32 v[84:85], v[24:25], v[26:27]
    v_pk_fma_f32 v[82:83], v[26:27], v[26:27], v[82:83]
    v_pk_add_f32 v[80:81], v[28:29], v[30:31]
    v_pk_fma_f32 v[82:83], v[28:29], v[28:29], v[82:83]
    v_pk_add_f32 v[84:85], v[84:85], v[80:81]
    v_pk_fma_f32 v[82:83], v[30:31], v[30:31], v[82:83]
    v_add_f32 v80, v84, v85
    v_add_f32 v81, v82, v83
    s_cmp_lt_u32 s4, 4
    s_cbranch_scc1 L_yp_49
    s_setprio 0
L_yp_49:
    v_permlane32_swap_b32 v80, v81
    v_add_f32 v80, v80, v81
    v_mov_b32 v81, v80
    s_nop 1
    v_permlane16_swap_b32 v80, v81
    v_add_f32 v80, v80, v81
    s_nop 1
    v_add_f32_dpp v80, v80, v80 quad_perm:[1,0,3,2] row_mask:0xf bank_mask:0xf
    s_nop 1
    v_add_f32_dpp v80, v80, v80 quad_perm:[2,3,0,1] row_mask:0xf bank_mask:0xf
    s_nop 1
    v_add_f32_dpp v80, v80, v80 row_half_mirror row_mask:0xf bank_mask:0xf
    s_nop 1
    v_add_f32_dpp v80, v80, v80 row_mirror row_mask:0xf bank_mask:0xf
    v_mul_f32 v80, 0x3b000000, v80
    v_mov_b32 v81, v80
    s_nop 1
    v_permlane32_swap_b32 v80, v81
    v_add_f32 v81, 0x3727c5ac, v81
    v_fma_f32 v81, -v80, v80, v81
    v_max_f32 v81, 0x3727c5ac, v81
    v_rsq_f32 v81, v81
    s_nop 0
    v_mul_f32 v80, v80, v81
    v_pk_fma_f32 v[72:73], v[24:25], v[80:81], v[80:81] op_sel:[0,1,0] op_sel_hi:[1,1,0] neg_lo:[0,0,1] neg_hi:[0,0,1]
    v_pk_fma_f32 v[74:75], v[26:27], v[80:81], v[80:81] op_sel:[0,1,0] op_sel_hi:[1,1,0] neg_lo:[0,0,1] neg_hi:[0,0,1]
    v_cvt_pk_bf16_f32 v64, v72, v73
    v_pk_fma_f32 v[76:77], v[28:29], v[80:81], v[80:81] op_sel:[0,1,0] op_sel_hi:[1,1,0] neg_lo:[0,0,1] neg_hi:[0,0,1]
    v_cvt_pk_bf16_f32 v65, v74, v75
    v_pk_fma_f32 v[78:79], v[30:31], v[80:81], v[80:81] op_sel:[0,1,0] op_sel_hi:[1,1,0] neg_lo:[0,0,1] neg_hi:[0,0,1]
    v_cvt_pk_bf16_f32 v66, v76, v77
    v_cvt_pk_bf16_f32 v67, v78, v79
    s_nop 1
    v_mfma_f32_16x16x32_bf16 v[84:87], v[64:67], a[0:3], 0
    v_mfma_f32_16x16x32_bf16 v[88:91], v[64:67], a[4:7], 0
    s_nop 6
    v_pk_mul_f32 v[72:73], v[84:85], v[40:41]
    v_pk_mul_f32 v[76:77], v[88:89], v[40:41]
    v_pk_mul_f32 v[74:75], v[86:87], v[42:43]
    v_pk_mul_f32 v[78:79], v[90:91], v[42:43]
    v_pk_fma_f32 v[72:73], v[88:89], v[44:45], v[72:73]
    v_pk_fma_f32 v[76:77], v[84:85], v[44:45], v[76:77] neg_lo:[1,0,0] neg_hi:[1,0,0]
    v_cvt_pk_bf16_f32 v64, v72, v76
    v_cvt_pk_bf16_f32 v65, v73, v77
    v_pk_fma_f32 v[74:75], v[90:91], v[46:47], v[74:75]
    v_pk_fma_f32 v[78:79], v[86:87], v[46:47], v[78:79] neg_lo:[1,0,0] neg_hi:[1,0,0]
    v_cvt_pk_bf16_f32 v66, v74, v78
    v_cvt_pk_bf16_f32 v67, v75, v79
    s_nop 1
    v_mfma_f32_16x16x32_bf16 v[84:87], a[8:11], v[64:67], 0
    v_mfma_f32_16x16x32_bf16 v[88:91], a[12:15], v[64:67], 0
    v_mfma_f32_16x16x32_bf16 v[92:95], a[16:19], v[64:67], 0
    v_mfma_f32_16x16x32_bf16 v[96:99], a[20:23], v[64:67], 0
    s_nop 5
    v_cvt_pk_bf16_f32 v68, v84, v88
    v_cvt_pk_bf16_f32 v69, v85, v89
    v_cvt_pk_bf16_f32 v70, v86, v90
    v_cvt_pk_bf16_f32 v71, v87, v91
    s_mov_b64 exec, s[76:77]
    v_cvt_pk_bf16_f32 v68, v92, v96
    v_cvt_pk_bf16_f32 v69, v93, v97
    v_cvt_pk_bf16_f32 v70, v94, v98
    v_cvt_pk_bf16_f32 v71, v95, v99
    s_mov_b64 exec, -1
    ds_write_b128 v12, v[68:71] offset:8320
    s_waitcnt lgkmcnt(0)
    s_barrier
    ds_read_b32 v72, v13 offset:8320
    ds_read_b32 v73, v13 offset:9360
    ds_read_b32 v74, v13 offset:10400
    ds_read_b32 v75, v13 offset:11440
    s_waitcnt lgkmcnt(3)
    v_and_b32 v72, -2, v72
    s_waitcnt lgkmcnt(2)
    v_and_b32 v73, -2, v73
    s_waitcnt lgkmcnt(1)
    v_and_b32 v74, -2, v74
    s_waitcnt lgkmcnt(0)
    v_and_b32 v75, -2, v75
    buffer_store_dwordx4 v[72:75], v4, s[8:11], 0 offen sc1
    s_cmp_lg_u32 s71, 0
    s_cbranch_scc1 L_p1_51
    s_cmp_ge_u32 s4, 4
    s_cbranch_scc1 L_sc_52
    v_lshl_add_u32 v84, v2, 3, s4
    v_lshlrev_b32 v85, 2, v3
    v_add_u32 v86, 0, v85
    v_mul_u32_u24 v86, v86, v84
    v_cvt_f32_u32 v87, v86
    v_mul_f32 v88, 0x3c000000, v87
    v_mul_f32 v87, 0x3a000000, v87
    v_cos_f32 v89, v88
    v_sin_f32 v90, v88
    v_cos_f32 v48, v87
    v_sin_f32 v52, v87
    v_cvt_pk_bf16_f32 v86, v89, v90
    v_cvt_pk_bf16_f32 v88, -v90, v89
    v_accvgpr_write_b32 a64, v86
    v_accvgpr_write_b32 a68, v88
    v_add_u32 v91, 0, v85
    v_lshl_add_u32 v91, v91, 3, s4
    v_mul_u32_u24 v91, v91, v2
    v_cvt_f32_u32 v92, v91
    v_mul_f32 v93, 0x3c000000, v92
    v_mul_f32 v92, 0x3a000000, v92
    v_cos_f32 v94, v93
    v_sin_f32 v95, v93
    v_cos_f32 v56, v92
    v_sin_f32 v60, v92
    v_cvt_pk_bf16_f32 v91, v94, v95
    v_cvt_pk_bf16_f32 v93, -v95, v94
    v_accvgpr_write_b32 a72, v91
    v_accvgpr_write_b32 a76, v93
    v_add_u32 v86, 1, v85
    v_mul_u32_u24 v86, v86, v84
    v_cvt_f32_u32 v87, v86
    v_mul_f32 v88, 0x3c000000, v87
    v_mul_f32 v87, 0x3a000000, v87
    v_cos_f32 v89, v88
    v_sin_f32 v90, v88
    v_cos_f32 v49, v87
    v_sin_f32 v53, v87
    v_cvt_pk_bf16_f32 v86, v89, v90
    v_cvt_pk_bf16_f32 v88, -v90, v89
    v_accvgpr_write_b32 a65, v86
    v_accvgpr_write_b32 a69, v88
    v_add_u32 v91, 1, v85
    v_lshl_add_u32 v91, v91, 3, s4
    v_mul_u32_u24 v91, v91, v2
    v_cvt_f32_u32 v92, v91
    v_mul_f32 v93, 0x3c000000, v92
    v_mul_f32 v92, 0x3a000000, v92
    v_cos_f32 v94, v93
    v_sin_f32 v95, v93
    v_cos_f32 v57, v92
    v_sin_f32 v61, v92
    v_cvt_pk_bf16_f32 v91, v94, v95
    v_cvt_pk_bf16_f32 v93, -v95, v94
    v_accvgpr_write_b32 a73, v91
    v_accvgpr_write_b32 a77, v93
    v_add_u32 v86, 2, v85
    v_mul_u32_u24 v86, v86, v84
    v_cvt_f32_u32 v87, v86
    v_mul_f32 v88, 0x3c000000, v87
    v_mul_f32 v87, 0x3a000000, v87
    v_cos_f32 v89, v88
    v_sin_f32 v90, v88
    v_cos_f32 v50, v87
    v_sin_f32 v54, v87
    v_cvt_pk_bf16_f32 v86, v89, v90
    v_cvt_pk_bf16_f32 v88, -v90, v89
    v_accvgpr_write_b32 a66, v86
    v_accvgpr_write_b32 a70, v88
    v_add_u32 v91, 2, v85
    v_lshl_add_u32 v91, v91, 3, s4
    v_mul_u32_u24 v91, v91, v2
    v_cvt_f32_u32 v92, v91
    v_mul_f32 v93, 0x3c000000, v92
    v_mul_f32 v92, 0x3a000000, v92
    v_cos_f32 v94, v93
    v_sin_f32 v95, v93
    v_cos_f32 v58, v92
    v_sin_f32 v62, v92
    v_cvt_pk_bf16_f32 v91, v94, v95
    v_cvt_pk_bf16_f32 v93, -v95, v94
    v_accvgpr_write_b32 a74, v91
    v_accvgpr_write_b32 a78, v93
    v_add_u32 v86, 3, v85
    v_mul_u32_u24 v86, v86, v84
    v_cvt_f32_u32 v87, v86
    v_mul_f32 v88, 0x3c000000, v87
    v_mul_f32 v87, 0x3a000000, v87
    v_cos_f32 v89, v88
    v_sin_f32 v90, v88
    v_cos_f32 v51, v87
    v_sin_f32 v55, v87
    v_cvt_pk_bf16_f32 v86, v89, v90
    v_cvt_pk_bf16_f32 v88, -v90, v89
    v_accvgpr_write_b32 a67, v86
    v_accvgpr_write_b32 a71, v88
    v_add_u32 v91, 3, v85
    v_lshl_add_u32 v91, v91, 3, s4
    v_mul_u32_u24 v91, v91, v2
    v_cvt_f32_u32 v92, v91
    v_mul_f32 v93, 0x3c000000, v92
    v_mul_f32 v92, 0x3a000000, v92
    v_cos_f32 v94, v93
    v_sin_f32 v95, v93
    v_cos_f32 v59, v92
    v_sin_f32 v63, v92
    v_cvt_pk_bf16_f32 v91, v94, v95
    v_cvt_pk_bf16_f32 v93, -v95, v94
    v_accvgpr_write_b32 a75, v91
    v_accvgpr_write_b32 a79, v93
    s_waitcnt vmcnt(0)
    s_branch L_sd_53
L_sc_52:
    s_waitcnt vmcnt(0)
L_sd_53:
    s_branch L_p0_50
L_p1_51:
    s_waitcnt vmcnt(0)
L_p0_50:
    s_mov_b32 s80, 0
L_poll_x_54:
    buffer_load_dword v64, v7, s[8:11], s64 offen sc1
    buffer_load_dword v65, v7, s[8:11], s65 offen sc1
    buffer_load_dword v66, v7, s[8:11], s66 offen sc1
    buffer_load_dword v67, v7, s[8:11], s67 offen sc1
    s_waitcnt vmcnt(0)
    v_or3_b32 v151, v64, v65, v66
    v_bitop3_b32 v151, v151, v67, 1 bitop3:0xa8
    v_cmp_ne_u32 vcc, 0, v151
    s_nop 0
    s_and_b64 exec, exec, vcc
    s_cbranch_scc0 L_done_x_55
    s_add_u32 s80, s80, 1
    s_cmp_lt_u32 s80, 1048576
    s_cbranch_scc1 L_poll_x_54
    s_mov_b64 exec, -1
    s_branch L_end
L_done_x_55:
    s_mov_b64 exec, -1
    s_cmp_lg_u32 s71, 0
    s_cbranch_scc1 L_fl_56
    buffer_load_dwordx4 v[144:147], v10, s[12:15], 0 offen sc1
L_fl_56:
    v_mfma_f32_16x16x32_bf16 v[68:71], v[64:67], a[24:27], 0
    v_mfma_f32_16x16x32_bf16 v[72:75], v[64:67], a[28:31], 0
    s_nop 7
    v_cvt_pk_bf16_f32 v76, v68, v72
    v_cvt_pk_bf16_f32 v77, v69, v73
    v_cvt_pk_bf16_f32 v78, v70, v74
    v_cvt_pk_bf16_f32 v79, v71, v75
    ds_write_b128 v17, v[76:79]
    s_waitcnt lgkmcnt(0)
    s_barrier
    ds_read_b32 v64, v18 offset:0
    ds_read_b32 v65, v18 offset:80
    ds_read_b32 v66, v18 offset:160
    ds_read_b32 v67, v18 offset:240
    v_mov_b32 v108, 1
    v_mov_b32 v109, 1
    v_mov_b32 v110, 1
    v_mov_b32 v111, 1
    buffer_store_dwordx4 v[108:111], v9, s[8:11], s60 offen sc1
    s_cmp_lt_u32 s4, 4
    s_cbranch_scc1 L_yp_57
    s_setprio 1
L_yp_57:
    s_waitcnt lgkmcnt(0)
    v_mfma_f32_16x16x32_bf16 v[68:71], v[64:67], a[64:67], 0
    v_mfma_f32_16x16x32_bf16 v[72:75], v[64:67], a[68:71], 0
    s_nop 6
    v_pk_mul_f32 v[80:81], v[68:69], v[48:49]
    v_pk_mul_f32 v[84:85], v[72:73], v[48:49]
    v_pk_mul_f32 v[82:83], v[70:71], v[50:51]
    v_pk_mul_f32 v[86:87], v[74:75], v[50:51]
    v_pk_fma_f32 v[80:81], v[72:73], v[52:53], v[80:81]
    v_pk_fma_f32 v[84:85], v[68:69], v[52:53], v[84:85] neg_lo:[1,0,0] neg_hi:[1,0,0]
    v_cvt_pk_bf16_f32 v64, v80, v84
    v_cvt_pk_bf16_f32 v65, v81, v85
    v_pk_fma_f32 v[82:83], v[74:75], v[54:55], v[82:83]
    v_pk_fma_f32 v[86:87], v[70:71], v[54:55], v[86:87] neg_lo:[1,0,0] neg_hi:[1,0,0]
    v_cvt_pk_bf16_f32 v66, v82, v86
    v_cvt_pk_bf16_f32 v67, v83, v87
    s_nop 1
    v_mfma_f32_16x16x32_bf16 v[68:71], a[32:35], v[64:67], 0
    v_mfma_f32_16x16x32_bf16 v[72:75], a[36:39], v[64:67], 0
    s_cmp_lg_u32 s71, 0
    s_cbranch_scc1 L_fl_58
    s_waitcnt vmcnt(1)
    v_lshlrev_b32 v32, 16, v144
    v_and_b32 v36, 0xffff0000, v144
    v_lshlrev_b32 v33, 16, v145
    v_and_b32 v37, 0xffff0000, v145
    v_lshlrev_b32 v34, 16, v146
    v_and_b32 v38, 0xffff0000, v146
    v_lshlrev_b32 v35, 16, v147
    v_and_b32 v39, 0xffff0000, v147
L_fl_58:
    s_nop 4
    v_pk_mul_f32 v[80:81], v[68:69], v[32:33]
    v_pk_mul_f32 v[84:85], v[68:69], v[36:37]
    v_pk_mul_f32 v[82:83], v[70:71], v[34:35]
    v_pk_mul_f32 v[86:87], v[70:71], v[38:39]
    v_pk_fma_f32 v[80:81], v[72:73], v[36:37], v[80:81] neg_lo:[1,0,0] neg_hi:[1,0,0]
    v_pk_fma_f32 v[84:85], v[72:73], v[32:33], v[84:85]
    v_cvt_pk_bf16_f32 v64, v80, -v84
    v_cvt_pk_bf16_f32 v65, v81, -v85
    v_pk_fma_f32 v[82:83], v[74:75], v[38:39], v[82:83] neg_lo:[1,0,0] neg_hi:[1,0,0]
    v_pk_fma_f32 v[86:87], v[74:75], v[34:35], v[86:87]
    v_cvt_pk_bf16_f32 v66, v82, -v86
    v_cvt_pk_bf16_f32 v67, v83, -v87
    s_cmp_lt_u32 s4, 4
    s_cbranch_scc1 L_yp_59
    s_setprio 0
L_yp_59:
    v_mfma_f32_16x16x32_bf16 v[68:71], v[64:67], a[32:35], 0
    v_mfma_f32_16x16x32_bf16 v[72:75], v[64:67], a[36:39], 0
    s_nop 6
    v_pk_mul_f32 v[80:81], v[68:69], v[56:57]
    v_pk_mul_f32 v[84:85], v[72:73], v[56:57]
    v_pk_mul_f32 v[82:83], v[70:71], v[58:59]
    v_pk_mul_f32 v[86:87], v[74:75], v[58:59]
    v_pk_fma_f32 v[80:81], v[72:73], v[60:61], v[80:81]
    v_pk_fma_f32 v[84:85], v[68:69], v[60:61], v[84:85] neg_lo:[1,0,0] neg_hi:[1,0,0]
    v_cvt_pk_bf16_f32 v64, v80, v84
    v_cvt_pk_bf16_f32 v65, v81, v85
    v_pk_fma_f32 v[82:83], v[74:75], v[62:63], v[82:83]
    v_pk_fma_f32 v[86:87], v[70:71], v[62:63], v[86:87] neg_lo:[1,0,0] neg_hi:[1,0,0]
    v_cvt_pk_bf16_f32 v66, v82, v86
    v_cvt_pk_bf16_f32 v67, v83, v87
    s_nop 1
    v_mfma_f32_16x16x32_bf16 v[68:71], v[64:67], a[72:75], 0
    v_mfma_f32_16x16x32_bf16 v[72:75], v[64:67], a[76:79], 0
    s_nop 7
    v_cvt_pk_bf16_f32 v76, v68, v72
    v_cvt_pk_bf16_f32 v77, v69, v73
    v_cvt_pk_bf16_f32 v78, v70, v74
    v_cvt_pk_bf16_f32 v79, v71, v75
    ds_write_b128 v19, v[76:79]
    s_waitcnt lgkmcnt(0)
    s_barrier
    ds_read_b32 v64, v20 offset:0
    ds_read_b32 v65, v20 offset:1344
    ds_read_b32 v66, v20 offset:2688
    ds_read_b32 v67, v20 offset:4032
    s_waitcnt lgkmcnt(0)
    v_mfma_f32_16x16x32_bf16 v[68:71], v[64:67], a[24:27], 0
    v_mfma_f32_16x16x32_bf16 v[72:75], v[64:67], a[28:31], 0
    s_nop 7
    v_cvt_pk_bf16_f32 v76, v68, -v72
    v_cvt_pk_bf16_f32 v77, v69, -v73
    v_cvt_pk_bf16_f32 v78, v70, -v74
    v_cvt_pk_bf16_f32 v79, v71, -v75
    v_and_b32 v76, -2, v76
    v_and_b32 v78, -2, v78
    buffer_store_dwordx4 v[76:79], v9, s[8:11], s60 offen sc1
    s_waitcnt vmcnt(0)
    s_cmp_eq_u32 s71, 0
    s_cbranch_scc1 L_xn_60
    s_lshl_b32 s82, s4, 11
    s_add_u32 s82, s82, 5376
    v_lshl_add_u32 v80, v21, 1, s82
    ds_write_b32 v80, v24 offset:0
    ds_write_b32 v80, v25 offset:64
    ds_write_b32 v80, v26 offset:128
    ds_write_b32 v80, v27 offset:192
    ds_write_b32 v80, v28 offset:1024
    ds_write_b32 v80, v29 offset:1088
    ds_write_b32 v80, v30 offset:1152
    ds_write_b32 v80, v31 offset:1216
    v_lshlrev_b32 v81, 6, v2
    v_lshl_add_u32 v81, v3, 4, v81
    v_add_u32 v81, s82, v81
    s_waitcnt lgkmcnt(0)
    ds_read_b128 v[100:103], v81
    ds_read_b128 v[104:107], v81 offset:1024
    s_waitcnt vmcnt(0)
    s_branch L_xo_61
L_xn_60:
    s_waitcnt vmcnt(0)
L_xo_61:
    s_mov_b32 s80, 0
L_poll_yh_62:
    buffer_load_dwordx4 v[64:67], v5, s[8:11], s60 offen sc1
    s_waitcnt vmcnt(0)
    v_bitop3_b32 v151, v64, v66, 1 bitop3:0xa8
    v_cmp_ne_u32 vcc, 0, v151
    s_nop 0
    s_and_b64 exec, exec, vcc
    s_cbranch_scc0 L_done_yh_63
    s_add_u32 s80, s80, 1
    s_cmp_lt_u32 s80, 1048576
    s_cbranch_scc1 L_poll_yh_62
    s_mov_b64 exec, -1
    s_branch L_end
L_done_yh_63:
    s_mov_b64 exec, -1
    ds_write_b32 v13, v64 offset:0
    ds_write_b32 v13, v65 offset:1040
    ds_write_b32 v13, v66 offset:2080
    ds_write_b32 v13, v67 offset:3120
    s_waitcnt lgkmcnt(0)
    s_barrier
    ds_read_b128 v[68:71], v12
    s_cmp_lg_u32 s71, 0
    s_cbranch_scc1 L_fl_64
    v_mov_b32 v144, 0
    v_mov_b32 v145, 0
    v_mov_b32 v146, 0
    v_mov_b32 v147, 0
    buffer_store_dwordx4 v[144:147], v4, s[8:11], 0 offen sc1
L_fl_64:
    s_cmp_lt_u32 s4, 4
    s_cbranch_scc1 L_yp_65
    s_setprio 1
L_yp_65:
    s_waitcnt lgkmcnt(0)
    v_mfma_f32_16x16x32_bf16 v[72:75], v[68:71], a[48:51], 0
    v_mfma_f32_16x16x32_bf16 v[76:79], v[68:71], a[52:55], 0
    v_mfma_f32_16x16x32_bf16 v[84:87], v[68:71], a[40:43], 0
    v_mfma_f32_16x16x32_bf16 v[88:91], v[68:71], a[44:47], 0
    s_mov_b64 exec, s[78:79]
    s_nop 5
    v_mov_b32 v84, v72
    v_mov_b32 v88, v76
    s_mov_b64 exec, -1
    v_pk_mul_f32 v[92:93], v[84:85], v[40:41]
    v_pk_mul_f32 v[96:97], v[88:89], v[40:41]
    v_pk_mul_f32 v[94:95], v[86:87], v[42:43]
    v_pk_mul_f32 v[98:99], v[90:91], v[42:43]
    v_pk_fma_f32 v[92:93], v[88:89], v[44:45], v[92:93] neg_lo:[1,0,0] neg_hi:[1,0,0]
    v_pk_fma_f32 v[96:97], v[84:85], v[44:45], v[96:97]
    v_cvt_pk_bf16_f32 v64, v92, v96
    v_cvt_pk_bf16_f32 v65, v93, v97
    v_pk_fma_f32 v[94:95], v[90:91], v[46:47], v[94:95] neg_lo:[1,0,0] neg_hi:[1,0,0]
    v_pk_fma_f32 v[98:99], v[86:87], v[46:47], v[98:99]
    v_cvt_pk_bf16_f32 v66, v94, v98
    v_cvt_pk_bf16_f32 v67, v95, v99
    s_cmp_lt_u32 s4, 4
    s_cbranch_scc1 L_yp_66
    s_setprio 0
L_yp_66:
    s_cmp_lg_u32 s71, 0
    s_cbranch_scc1 L_last_67
    v_mfma_f32_16x16x32_bf16 v[72:75], a[56:59], v[64:67], 0
    v_mfma_f32_16x16x32_bf16 v[76:79], a[60:63], v[64:67], 0
    s_nop 6
    v_pk_add_f32 v[24:25], v[72:73], v[24:25]
    v_pk_add_f32 v[26:27], v[74:75], v[26:27]
    v_pk_add_f32 v[28:29], v[76:77], v[28:29]
    v_pk_add_f32 v[30:31], v[78:79], v[30:31]
    v_pk_mul_f32 v[82:83], v[24:25], v[24:25]
    v_pk_add_f32 v[84:85], v[24:25], v[26:27]
    v_pk_fma_f32 v[82:83], v[26:27], v[26:27], v[82:83]
    v_pk_add_f32 v[80:81], v[28:29], v[30:31]
    v_pk_fma_f32 v[82:83], v[28:29], v[28:29], v[82:83]
    v_pk_add_f32 v[84:85], v[84:85], v[80:81]
    v_pk_fma_f32 v[82:83], v[30:31], v[30:31], v[82:83]
    v_add_f32 v80, v84, v85
    v_add_f32 v81, v82, v83
    s_nop 1
    v_permlane32_swap_b32 v80, v81
    v_add_f32 v80, v80, v81
    v_mov_b32 v81, v80
    s_nop 1
    v_permlane16_swap_b32 v80, v81
    v_add_f32 v80, v80, v81
    s_nop 1
    v_add_f32_dpp v80, v80, v80 quad_perm:[1,0,3,2] row_mask:0xf bank_mask:0xf
    s_nop 1
    v_add_f32_dpp v80, v80, v80 quad_perm:[2,3,0,1] row_mask:0xf bank_mask:0xf
    s_nop 1
    v_add_f32_dpp v80, v80, v80 row_half_mirror row_mask:0xf bank_mask:0xf
    s_nop 1
    v_add_f32_dpp v80, v80, v80 row_mirror row_mask:0xf bank_mask:0xf
    v_mul_f32 v80, 0x3b000000, v80
    v_mov_b32 v81, v80
    s_nop 1
    v_permlane32_swap_b32 v80, v81
    v_add_f32 v81, 0x3727c5ac, v81
    v_fma_f32 v81, -v80, v80, v81
    v_max_f32 v81, 0x3727c5ac, v81
    v_rsq_f32 v81, v81
    s_nop 0
    v_mul_f32 v80, v80, v81
    v_pk_fma_f32 v[96:97], v[24:25], v[80:81], v[80:81] op_sel:[0,1,0] op_sel_hi:[1,1,0] neg_lo:[0,0,1] neg_hi:[0,0,1]
    v_pk_fma_f32 v[98:99], v[26:27], v[80:81], v[80:81] op_sel:[0,1,0] op_sel_hi:[1,1,0] neg_lo:[0,0,1] neg_hi:[0,0,1]
    v_cvt_pk_bf16_f32 v64, v96, v97
    v_pk_fma_f32 v[100:101], v[28:29], v[80:81], v[80:81] op_sel:[0,1,0] op_sel_hi:[1,1,0] neg_lo:[0,0,1] neg_hi:[0,0,1]
    v_cvt_pk_bf16_f32 v65, v98, v99
    v_pk_fma_f32 v[102:103], v[30:31], v[80:81], v[80:81] op_sel:[0,1,0] op_sel_hi:[1,1,0] neg_lo:[0,0,1] neg_hi:[0,0,1]
    v_cvt_pk_bf16_f32 v66, v100, v101
    v_cvt_pk_bf16_f32 v67, v102, v103
    ds_write_b128 v12, v[64:67] offset:8320
    s_waitcnt lgkmcnt(0)
    s_barrier
    ds_read_u16_d16 v84, v11 offset:8320
    ds_read_u16_d16_hi v88, v11 offset:9360
    ds_read_u16_d16 v85, v11 offset:10400
    ds_read_u16_d16_hi v89, v11 offset:11440
    ds_read_u16_d16 v86, v11 offset:12480
    ds_read_u16_d16_hi v90, v11 offset:13520
    ds_read_u16_d16 v87, v11 offset:14560
    ds_read_u16_d16_hi v91, v11 offset:15600
    s_waitcnt lgkmcnt(6)
    v_or3_b32 v92, v84, v88, 1
    s_waitcnt lgkmcnt(4)
    v_or3_b32 v93, v85, v89, 1
    s_waitcnt lgkmcnt(2)
    v_or3_b32 v94, v86, v90, 1
    s_waitcnt lgkmcnt(0)
    v_or3_b32 v95, v87, v91, 1
    buffer_store_dwordx4 v[92:95], v4, s[8:11], 0 offen sc1
    s_waitcnt vmcnt(0)
    v_pk_fma_f32 v[24:25], v[96:97], v[152:153], v[24:25]
    v_pk_fma_f32 v[26:27], v[98:99], v[154:155], v[26:27]
    v_pk_fma_f32 v[28:29], v[100:101], v[156:157], v[28:29]
    v_pk_fma_f32 v[30:31], v[102:103], v[158:159], v[30:31]
    s_mov_b32 s71, 1
    s_waitcnt vmcnt(0)
    s_cmp_ge_u32 s4, 4
    s_cbranch_scc1 L_ap_68
    ds_read_b128 v[64:67], v15 offset:2144
    ds_read_b128 v[68:71], v15 offset:2112
    ds_read_b128 v[80:83], v15 offset:2080
    ds_read_b128 v[84:87], v15 offset:2048
    ds_read_b128 v[96:99], v15 offset:2016
    ds_read_b128 v[100:103], v15 offset:1984
    s_waitcnt lgkmcnt(0)
L_ap_68:
    s_branch L_layer
L_last_67:
    v_mfma_f32_16x16x32_bf16 v[72:75], v[64:67], a[56:59], 0
    v_mfma_f32_16x16x32_bf16 v[76:79], v[64:67], a[60:63], 0
    s_nop 6
    v_pk_add_f32 v[72:73], v[72:73], v[100:101]
    v_pk_add_f32 v[74:75], v[74:75], v[102:103]
    v_pk_add_f32 v[76:77], v[76:77], v[104:105]
    v_pk_add_f32 v[78:79], v[78:79], v[106:107]
    v_cvt_pk_bf16_f32 v64, v72, v73
    v_cvt_pk_bf16_f32 v65, v74, v75
    v_cvt_pk_bf16_f32 v66, v76, v77
    v_cvt_pk_bf16_f32 v67, v78, v79
    s_nop 0
    v_permlane16_swap_b32 v64, v66
    v_permlane16_swap_b32 v65, v67
    buffer_store_dwordx4 v[64:67], v22, s[12:15], s68 offen sc1
L_end:
    s_endpgm
.p2align 6
.type L_table,@object
L_table:
.long 0x3f803f80,0x3f803f80,0x3f803f80,0x3f803f80,0x3f7b3f80,0x3f553f6d,0xbf7bbf80,0xbf55bf6d
.long 0x3f6d3f80,0x3ec43f35,0x3f6d3f80,0x3ec43f35,0x3f553f80,0xbe483ec4,0xbf55bf80,0x3e48bec4
.long 0x3f353f80,0xbf350000,0x3f353f80,0xbf350000,0x3f0e3f80,0xbf7bbec4,0xbf0ebf80,0x3f7b3ec4
.long 0x3ec43f80,0xbf6dbf35,0x3ec43f80,0xbf6dbf35,0x3e483f80,0xbf0ebf6d,0xbe48bf80,0x3f0e3f6d
.long 0x3f80,0xbf80,0x3f80,0xbf80,0xbe483f80,0x3f0ebf6d,0x3e48bf80,0xbf0e3f6d
.long 0xbec43f80,0x3f6dbf35,0xbec43f80,0x3f6dbf35,0xbf0e3f80,0x3f7bbec4,0x3f0ebf80,0xbf7b3ec4
.long 0xbf353f80,0x3f350000,0xbf353f80,0x3f350000,0xbf553f80,0x3e483ec4,0x3f55bf80,0xbe48bec4
.long 0xbf6d3f80,0xbec43f35,0xbf6d3f80,0xbec43f35,0xbf7b3f80,0xbf553f6d,0x3f7bbf80,0x3f55bf6d
.long 0x3f803f80,0x3f803f80,0x3f803f80,0x3f803f80,0x3f0e3f35,0x3e483ec4,0xbf0ebf35,0xbe48bec4
.long 0xbec40000,0xbf6dbf35,0xbec40000,0xbf6dbf35,0xbf7bbf35,0xbf0ebf6d,0x3f7b3f35,0x3f0e3f6d
.long 0xbf35bf80,0x3f350000,0xbf35bf80,0x3f350000,0x3e48bf35,0x3f553f6d,0xbe483f35,0xbf55bf6d
.long 0x3f6d0000,0xbec43f35,0x3f6d0000,0xbec43f35,0x3f553f35,0xbf7bbec4,0xbf55bf35,0x3f7b3ec4
.long 0x3f80,0xbf80,0x3f80,0xbf80,0xbf553f35,0x3f7bbec4,0x3f55bf35,0xbf7b3ec4
.long 0xbf6d0000,0x3ec43f35,0xbf6d0000,0x3ec43f35,0xbe48bf35,0xbf553f6d,0x3e483f35,0x3f55bf6d
.long 0x3f35bf80,0xbf350000,0x3f35bf80,0xbf350000,0x3f7bbf35,0x3f0ebf6d,0xbf7b3f35,0xbf0e3f6d
.long 0x3ec40000,0x3f6dbf35,0x3ec40000,0x3f6dbf35,0xbf0e3f35,0xbe483ec4,0x3f0ebf35,0x3e48bec4
.long 0x3f803f80,0x3f803f80,0x3f803f80,0x3f803f80,0xbe480000,0xbf0ebec4,0x3e480000,0x3f0e3ec4
.long 0xbf6dbf80,0xbec4bf35,0xbf6dbf80,0xbec4bf35,0x3f0e0000,0x3f7b3f6d,0xbf0e0000,0xbf7bbf6d
.long 0x3f353f80,0xbf350000,0x3f353f80,0xbf350000,0xbf550000,0xbe48bf6d,0x3f550000,0x3e483f6d
.long 0xbec4bf80,0x3f6d3f35,0xbec4bf80,0x3f6d3f35,0x3f7b0000,0xbf553ec4,0xbf7b0000,0x3f55bec4
.long 0x3f80,0xbf80,0x3f80,0xbf80,0xbf7b0000,0x3f553ec4,0x3f7b0000,0xbf55bec4
.long 0x3ec4bf80,0xbf6d3f35,0x3ec4bf80,0xbf6d3f35,0x3f550000,0x3e48bf6d,0xbf550000,0xbe483f6d
.long 0xbf353f80,0x3f350000,0xbf353f80,0x3f350000,0xbf0e0000,0xbf7b3f6d,0x3f0e0000,0x3f7bbf6d
.long 0x3f6dbf80,0x3ec4bf35,0x3f6dbf80,0x3ec4bf35,0x3e480000,0x3f0ebec4,0xbe480000,0xbf0e3ec4
.long 0x3f803f80,0x3f803f80,0x3f803f80,0x3f803f80,0xbf55bf35,0xbf7bbf6d,0x3f553f35,0x3f7b3f6d
.long 0x3ec40000,0x3f6d3f35,0x3ec40000,0x3f6d3f35,0x3e483f35,0xbf55bec4,0xbe48bf35,0x3f553ec4
.long 0xbf35bf80,0x3f350000,0xbf35bf80,0x3f350000,0x3f7b3f35,0xbf0e3ec4,0xbf7bbf35,0x3f0ebec4
.long 0xbf6d0000,0x3ec4bf35,0xbf6d0000,0x3ec4bf35,0x3f0ebf35,0xbe483f6d,0xbf0e3f35,0x3e48bf6d
.long 0x3f80,0xbf80,0x3f80,0xbf80,0xbf0ebf35,0x3e483f6d,0x3f0e3f35,0xbe48bf6d
.long 0x3f6d0000,0xbec4bf35,0x3f6d0000,0xbec4bf35,0xbf7b3f35,0x3f0e3ec4,0x3f7bbf35,0xbf0ebec4
.long 0x3f35bf80,0xbf350000,0x3f35bf80,0xbf350000,0xbe483f35,0x3f55bec4,0x3e48bf35,0xbf553ec4
.long 0xbec40000,0xbf6d3f35,0xbec40000,0xbf6d3f35,0x3f55bf35,0x3f7bbf6d,0xbf553f35,0xbf7b3f6d
.long 0xbf803f80,0xbf803f80,0xbf803f80,0xbf803f80,0xbe480000,0xbf0ebec4,0x3e480000,0x3f0e3ec4
.long 0xbec40000,0xbf6dbf35,0xbec40000,0xbf6dbf35,0xbf0e0000,0xbf7bbf6d,0x3f0e0000,0x3f7b3f6d
.long 0xbf350000,0xbf35bf80,0xbf350000,0xbf35bf80,0xbf550000,0xbe48bf6d,0x3f550000,0x3e483f6d
.long 0xbf6d0000,0x3ec4bf35,0xbf6d0000,0x3ec4bf35,0xbf7b0000,0x3f55bec4,0x3f7b0000,0xbf553ec4
.long 0xbf800000,0x3f800000,0xbf800000,0x3f800000,0xbf7b0000,0x3f553ec4,0x3f7b0000,0xbf55bec4
.long 0xbf6d0000,0x3ec43f35,0xbf6d0000,0x3ec43f35,0xbf550000,0xbe483f6d,0x3f550000,0x3e48bf6d
.long 0xbf350000,0xbf353f80,0xbf350000,0xbf353f80,0xbf0e0000,0xbf7b3f6d,0x3f0e0000,0x3f7bbf6d
.long 0xbec40000,0xbf6d3f35,0xbec40000,0xbf6d3f35,0xbe480000,0xbf0e3ec4,0x3e480000,0x3f0ebec4
.long 0xbf803f80,0xbf803f80,0xbf803f80,0xbf803f80,0xbf55bf35,0xbf7bbf6d,0x3f553f35,0x3f7b3f6d
.long 0xbf6dbf80,0xbec4bf35,0xbf6dbf80,0xbec4bf35,0xbe48bf35,0x3f553ec4,0x3e483f35,0xbf55bec4
.long 0x3f350000,0x3f353f80,0x3f350000,0x3f353f80,0x3f7b3f35,0xbf0e3ec4,0xbf7bbf35,0x3f0ebec4
.long 0x3ec43f80,0xbf6dbf35,0x3ec43f80,0xbf6dbf35,0xbf0e3f35,0x3e48bf6d,0x3f0ebf35,0xbe483f6d
.long 0xbf800000,0x3f800000,0xbf800000,0x3f800000,0xbf0ebf35,0x3e483f6d,0x3f0e3f35,0xbe48bf6d
.long 0x3ec4bf80,0xbf6d3f35,0x3ec4bf80,0xbf6d3f35,0x3f7bbf35,0xbf0ebec4,0xbf7b3f35,0x3f0e3ec4
.long 0x3f350000,0x3f35bf80,0x3f350000,0x3f35bf80,0xbe483f35,0x3f55bec4,0x3e48bf35,0xbf553ec4
.long 0xbf6d3f80,0xbec43f35,0xbf6d3f80,0xbec43f35,0xbf553f35,0xbf7b3f6d,0x3f55bf35,0x3f7bbf6d
.long 0xbf803f80,0xbf803f80,0xbf803f80,0xbf803f80,0xbf7bbf80,0xbf55bf6d,0x3f7b3f80,0x3f553f6d
.long 0x3ec40000,0x3f6d3f35,0x3ec40000,0x3f6d3f35,0x3f553f80,0xbe483ec4,0xbf55bf80,0x3e48bec4
.long 0xbf350000,0xbf35bf80,0xbf350000,0xbf35bf80,0xbf0ebf80,0x3f7b3ec4,0x3f0e3f80,0xbf7bbec4
.long 0x3f6d0000,0xbec43f35,0x3f6d0000,0xbec43f35,0x3e483f80,0xbf0ebf6d,0xbe48bf80,0x3f0e3f6d
.long 0xbf800000,0x3f800000,0xbf800000,0x3f800000,0x3e48bf80,0xbf0e3f6d,0xbe483f80,0x3f0ebf6d
.long 0x3f6d0000,0xbec4bf35,0x3f6d0000,0xbec4bf35,0xbf0e3f80,0x3f7bbec4,0x3f0ebf80,0xbf7b3ec4
.long 0xbf350000,0xbf353f80,0xbf350000,0xbf353f80,0x3f55bf80,0xbe48bec4,0xbf553f80,0x3e483ec4
.long 0x3ec40000,0x3f6dbf35,0x3ec40000,0x3f6dbf35,0xbf7b3f80,0xbf553f6d,0x3f7bbf80,0x3f55bf6d
.long 0xbf803f80,0xbf803f80,0xbf803f80,0xbf803f80,0xbf0ebf35,0xbe48bec4,0x3f0e3f35,0x3e483ec4
.long 0x3f6d3f80,0x3ec43f35,0x3f6d3f80,0x3ec43f35,0xbf7bbf35,0xbf0ebf6d,0x3f7b3f35,0x3f0e3f6d
.long 0x3f350000,0x3f353f80,0x3f350000,0x3f353f80,0xbe483f35,0xbf55bf6d,0x3e48bf35,0x3f553f6d
.long 0xbec4bf80,0x3f6d3f35,0xbec4bf80,0x3f6d3f35,0x3f553f35,0xbf7bbec4,0xbf55bf35,0x3f7b3ec4
.long 0xbf800000,0x3f800000,0xbf800000,0x3f800000,0x3f55bf35,0xbf7b3ec4,0xbf553f35,0x3f7bbec4
.long 0xbec43f80,0x3f6dbf35,0xbec43f80,0x3f6dbf35,0xbe48bf35,0xbf553f6d,0x3e483f35,0x3f55bf6d
.long 0x3f350000,0x3f35bf80,0x3f350000,0x3f35bf80,0xbf7b3f35,0xbf0e3f6d,0x3f7bbf35,0x3f0ebf6d
.long 0x3f6dbf80,0x3ec4bf35,0x3f6dbf80,0x3ec4bf35,0xbf0e3f35,0xbe483ec4,0x3f0ebf35,0x3e48bec4
.long 0x3f80,0x3f80,0x3f80,0x3f80,0x3f80,0x3ec43f6d,0x3f353f35,0x3f6d3ec4
.long 0x3f80,0x3f353f35,0x3f800000,0x3f35bf35,0x3f80,0x3f6d3ec4,0x3f35bf35,0xbec4bf6d
.long 0x3f80,0x3f800000,0xbf80,0xbf800000,0x3f80,0x3f6dbec4,0xbf35bf35,0xbec43f6d
.long 0x3f80,0x3f35bf35,0xbf800000,0x3f353f35,0x3f80,0x3ec4bf6d,0xbf353f35,0x3f6dbec4
.long 0x3f80,0xbf80,0x3f80,0xbf80,0x3f80,0xbec4bf6d,0x3f353f35,0xbf6dbec4
.long 0x3f80,0xbf35bf35,0x3f800000,0xbf353f35,0x3f80,0xbf6dbec4,0x3f35bf35,0x3ec43f6d
.long 0x3f80,0xbf800000,0xbf80,0x3f800000,0x3f80,0xbf6d3ec4,0xbf35bf35,0x3ec4bf6d
.long 0x3f80,0xbf353f35,0xbf800000,0xbf35bf35,0x3f80,0xbec43f6d,0xbf353f35,0xbf6d3ec4
.long 0x3f80,0x3f80,0x3f80,0x3f80,0x3f800000,0x3f6dbec4,0x3f35bf35,0x3ec4bf6d
.long 0xbf80,0xbf35bf35,0xbf800000,0xbf353f35,0xbf800000,0xbec43f6d,0x3f353f35,0x3f6dbec4
.long 0x3f80,0x3f800000,0xbf80,0xbf800000,0x3f800000,0xbec4bf6d,0xbf353f35,0x3f6d3ec4
.long 0xbf80,0xbf353f35,0x3f800000,0xbf35bf35,0xbf800000,0x3f6d3ec4,0xbf35bf35,0x3ec43f6d
.long 0x3f80,0xbf80,0x3f80,0xbf80,0x3f800000,0xbf6d3ec4,0x3f35bf35,0xbec43f6d
.long 0xbf80,0x3f353f35,0xbf800000,0x3f35bf35,0xbf800000,0x3ec4bf6d,0x3f353f35,0xbf6d3ec4
.long 0x3f80,0xbf800000,0xbf80,0x3f800000,0x3f800000,0x3ec43f6d,0xbf353f35,0xbf6dbec4
.long 0xbf80,0x3f35bf35,0x3f800000,0x3f353f35,0xbf800000,0xbf6dbec4,0xbf35bf35,0xbec4bf6d
.long 0x3f80,0x3f80,0x3f80,0x3f80,0xbf80,0xbec4bf6d,0xbf35bf35,0xbf6dbec4
.long 0x3f80,0x3f353f35,0x3f800000,0x3f35bf35,0xbf80,0xbf6dbec4,0xbf353f35,0x3ec43f6d
.long 0x3f80,0x3f800000,0xbf80,0xbf800000,0xbf80,0xbf6d3ec4,0x3f353f35,0x3ec4bf6d
.long 0x3f80,0x3f35bf35,0xbf800000,0x3f353f35,0xbf80,0xbec43f6d,0x3f35bf35,0xbf6d3ec4
.long 0x3f80,0xbf80,0x3f80,0xbf80,0xbf80,0x3ec43f6d,0xbf35bf35,0x3f6d3ec4
.long 0x3f80,0xbf35bf35,0x3f800000,0xbf353f35,0xbf80,0x3f6d3ec4,0xbf353f35,0xbec4bf6d
.long 0x3f80,0xbf800000,0xbf80,0x3f800000,0xbf80,0x3f6dbec4,0x3f353f35,0xbec43f6d
.long 0x3f80,0xbf353f35,0xbf800000,0xbf35bf35,0xbf80,0x3ec4bf6d,0x3f35bf35,0x3f6dbec4
.long 0x3f80,0x3f80,0x3f80,0x3f80,0xbf800000,0xbf6d3ec4,0xbf353f35,0xbec43f6d
.long 0xbf80,0xbf35bf35,0xbf800000,0xbf353f35,0x3f800000,0x3ec4bf6d,0xbf35bf35,0xbf6d3ec4
.long 0x3f80,0x3f800000,0xbf80,0xbf800000,0xbf800000,0x3ec43f6d,0x3f35bf35,0xbf6dbec4
.long 0xbf80,0xbf353f35,0x3f800000,0xbf35bf35,0x3f800000,0xbf6dbec4,0x3f353f35,0xbec4bf6d
.long 0x3f80,0xbf80,0x3f80,0xbf80,0xbf800000,0x3f6dbec4,0xbf353f35,0x3ec4bf6d
.long 0xbf80,0x3f353f35,0xbf800000,0x3f35bf35,0x3f800000,0xbec43f6d,0xbf35bf35,0x3f6dbec4
.long 0x3f80,0xbf800000,0xbf80,0x3f800000,0xbf800000,0xbec4bf6d,0x3f35bf35,0x3f6d3ec4
.long 0xbf80,0x3f35bf35,0x3f800000,0x3f353f35,0x3f800000,0x3f6d3ec4,0x3f353f35,0x3ec43f6d
.long 0x3f800000,0x3f800000,0x3f800000,0x3f800000,0x3f800000,0x3f6dbec4,0x3f35bf35,0x3ec4bf6d
.long 0x3f800000,0x3f35bf35,0xbf80,0xbf35bf35,0x3f800000,0x3ec4bf6d,0xbf35bf35,0xbf6d3ec4
.long 0x3f800000,0xbf80,0xbf800000,0x3f80,0x3f800000,0xbec4bf6d,0xbf353f35,0x3f6d3ec4
.long 0x3f800000,0xbf35bf35,0x3f80,0x3f35bf35,0x3f800000,0xbf6dbec4,0x3f353f35,0xbec4bf6d
.long 0xbf800000,0x3f800000,0xbf800000,0x3f800000,0xbf800000,0x3f6dbec4,0xbf353f35,0x3ec4bf6d
.long 0xbf800000,0x3f35bf35,0x3f80,0xbf35bf35,0xbf800000,0x3ec4bf6d,0x3f353f35,0xbf6d3ec4
.long 0xbf800000,0xbf80,0x3f800000,0x3f80,0xbf800000,0xbec4bf6d,0x3f35bf35,0x3f6d3ec4
.long 0xbf800000,0xbf35bf35,0xbf80,0x3f35bf35,0xbf800000,0xbf6dbec4,0xbf35bf35,0xbec4bf6d
.long 0x3f800000,0x3f800000,0x3f800000,0x3f800000,0xbf80,0xbec4bf6d,0xbf35bf35,0xbf6dbec4
.long 0xbf800000,0xbf353f35,0x3f80,0x3f353f35,0x3f80,0x3f6d3ec4,0x3f35bf35,0xbec4bf6d
.long 0x3f800000,0xbf80,0xbf800000,0x3f80,0xbf80,0xbf6d3ec4,0x3f353f35,0x3ec4bf6d
.long 0xbf800000,0x3f353f35,0xbf80,0xbf353f35,0x3f80,0x3ec4bf6d,0xbf353f35,0x3f6dbec4
.long 0xbf800000,0x3f800000,0xbf800000,0x3f800000,0x3f80,0xbec4bf6d,0x3f353f35,0xbf6dbec4
.long 0x3f800000,0xbf353f35,0xbf80,0x3f353f35,0xbf80,0x3f6d3ec4,0xbf353f35,0xbec4bf6d
.long 0xbf800000,0xbf80,0x3f800000,0x3f80,0x3f80,0xbf6d3ec4,0xbf35bf35,0x3ec4bf6d
.long 0x3f800000,0x3f353f35,0x3f80,0xbf353f35,0xbf80,0x3ec4bf6d,0x3f35bf35,0x3f6dbec4
.long 0x3f800000,0x3f800000,0x3f800000,0x3f800000,0xbf800000,0xbf6d3ec4,0xbf353f35,0xbec43f6d
.long 0x3f800000,0x3f35bf35,0xbf80,0xbf35bf35,0xbf800000,0xbec43f6d,0x3f353f35,0x3f6dbec4
.long 0x3f800000,0xbf80,0xbf800000,0x3f80,0xbf800000,0x3ec43f6d,0x3f35bf35,0xbf6dbec4
.long 0x3f800000,0xbf35bf35,0x3f80,0x3f35bf35,0xbf800000,0x3f6d3ec4,0xbf35bf35,0x3ec43f6d
.long 0xbf800000,0x3f800000,0xbf800000,0x3f800000,0x3f800000,0xbf6d3ec4,0x3f35bf35,0xbec43f6d
.long 0xbf800000,0x3f35bf35,0x3f80,0xbf35bf35,0x3f800000,0xbec43f6d,0xbf35bf35,0x3f6dbec4
.long 0xbf800000,0xbf80,0x3f800000,0x3f80,0x3f800000,0x3ec43f6d,0xbf353f35,0xbf6dbec4
.long 0xbf800000,0xbf35bf35,0xbf80,0x3f35bf35,0x3f800000,0x3f6d3ec4,0x3f353f35,0x3ec43f6d
.long 0x3f800000,0x3f800000,0x3f800000,0x3f800000,0x3f80,0x3ec43f6d,0x3f353f35,0x3f6d3ec4
.long 0xbf800000,0xbf353f35,0x3f80,0x3f353f35,0xbf80,0xbf6dbec4,0xbf353f35,0x3ec43f6d
.long 0x3f800000,0xbf80,0xbf800000,0x3f80,0x3f80,0x3f6dbec4,0xbf35bf35,0xbec43f6d
.long 0xbf800000,0x3f353f35,0xbf80,0xbf353f35,0xbf80,0xbec43f6d,0x3f35bf35,0xbf6d3ec4
.long 0xbf800000,0x3f800000,0xbf800000,0x3f800000,0xbf80,0x3ec43f6d,0xbf35bf35,0x3f6d3ec4
.long 0x3f800000,0xbf353f35,0xbf80,0x3f353f35,0x3f80,0xbf6dbec4,0x3f35bf35,0x3ec43f6d
.long 0xbf800000,0xbf80,0x3f800000,0x3f80,0xbf80,0x3f6dbec4,0x3f353f35,0xbec43f6d
.long 0x3f800000,0x3f353f35,0x3f80,0xbf353f35,0x3f80,0xbec43f6d,0xbf353f35,0xbf6d3ec4
.long 0x3f800000,0x3f7b0000,0x3f6d0000,0x3f550000,0x3f80,0x3f6d,0x3f35,0x3ec4
.long 0x3f80,0x3f35,0x0,0xbf35,0x3f80,0x3ec4,0xbf35,0xbf6d
.long 0x3f80,0x0,0xbf80,0x0,0x3f80,0xbec4,0xbf35,0x3f6d
.long 0x3f80,0xbf35,0x0,0x3f35,0x3f80,0xbf6d,0x3f35,0xbec4
.long 0x3f80,0xbf80,0x3f80,0xbf80,0x3f800000,0x3f550000,0x3ec40000,0xbe480000
.long 0x3f800000,0x3f0e0000,0xbec40000,0xbf7b0000,0x3f800000,0x3e480000,0xbf6d0000,0xbf0e0000
.long 0x3f800000,0xbe480000,0xbf6d0000,0x3f0e0000,0x3f800000,0xbf0e0000,0xbec40000,0x3f7b0000
.long 0x3f800000,0xbf550000,0x3ec40000,0x3e480000,0x3f800000,0xbf7b0000,0x3f6d0000,0xbf550000
.long 0x3f350000,0x3f0e0000,0x3ec40000,0x3e480000,0x0,0xbec4,0xbf35,0xbf6d
.long 0xbf80,0xbf35,0x0,0x3f35,0x0,0x3f6d,0x3f35,0xbec4
.long 0x3f80,0x0,0xbf80,0x0,0x0,0xbf6d,0x3f35,0x3ec4
.long 0xbf80,0x3f35,0x0,0xbf35,0x0,0x3ec4,0xbf35,0x3f6d
.long 0x3f80,0xbf80,0x3f80,0xbf80,0xbf350000,0xbf7b0000,0xbf6d0000,0xbf0e0000
.long 0xbf350000,0x3e480000,0x3f6d0000,0x3f550000,0x3f350000,0x3f550000,0xbec40000,0xbf7b0000
.long 0x3f350000,0xbf550000,0xbec40000,0x3f7b0000,0xbf350000,0xbe480000,0x3f6d0000,0xbf550000
.long 0xbf350000,0x3f7b0000,0xbf6d0000,0x3f0e0000,0x3f350000,0xbf0e0000,0x3ec40000,0xbe480000
.long 0x0,0xbe480000,0xbec40000,0xbf0e0000,0xbf80,0xbf6d,0xbf35,0xbec4
.long 0x3f80,0x3f35,0x0,0xbf35,0xbf80,0xbec4,0x3f35,0x3f6d
.long 0x3f80,0x0,0xbf80,0x0,0xbf80,0x3ec4,0x3f35,0xbf6d
.long 0x3f80,0xbf35,0x0,0x3f35,0xbf80,0x3f6d,0xbf35,0x3ec4
.long 0x3f80,0xbf80,0x3f80,0xbf80,0x0,0x3f0e0000,0x3f6d0000,0x3f7b0000
.long 0x0,0xbf550000,0xbf6d0000,0xbe480000,0x0,0x3f7b0000,0x3ec40000,0xbf550000
.long 0x0,0xbf7b0000,0x3ec40000,0x3f550000,0x0,0x3f550000,0xbf6d0000,0x3e480000
.long 0x0,0xbf0e0000,0x3f6d0000,0xbf7b0000,0x0,0x3e480000,0xbec40000,0x3f0e0000
.long 0xbf350000,0xbf550000,0xbf6d0000,0xbf7b0000,0x0,0x3ec4,0x3f35,0x3f6d
.long 0xbf80,0xbf35,0x0,0x3f35,0x0,0xbf6d,0xbf35,0x3ec4
.long 0x3f80,0x0,0xbf80,0x0,0x0,0x3f6d,0xbf35,0xbec4
.long 0xbf80,0x3f35,0x0,0xbf35,0x0,0xbec4,0x3f35,0xbf6d
.long 0x3f80,0xbf80,0x3f80,0xbf80,0x3f350000,0x3e480000,0xbec40000,0xbf550000
.long 0x3f350000,0x3f7b0000,0x3ec40000,0xbf0e0000,0xbf350000,0x3f0e0000,0x3f6d0000,0xbe480000
.long 0xbf350000,0xbf0e0000,0x3f6d0000,0x3e480000,0x3f350000,0xbf7b0000,0x3ec40000,0x3f0e0000
.long 0x3f350000,0xbe480000,0xbec40000,0x3f550000,0xbf350000,0x3f550000,0xbf6d0000,0x3f7b0000
.long 0x0,0xbe480000,0xbec40000,0xbf0e0000,0x0,0xbec4,0xbf35,0xbf6d
.long 0x0,0xbf35,0xbf80,0xbf35,0x0,0xbf6d,0xbf35,0x3ec4
.long 0x0,0xbf80,0x0,0x3f80,0x0,0xbf6d,0x3f35,0x3ec4
.long 0x0,0xbf35,0x3f80,0xbf35,0x0,0xbec4,0x3f35,0xbf6d
.long 0x0,0x0,0x0,0x0,0x0,0xbf0e0000,0xbf6d0000,0xbf7b0000
.long 0x0,0xbf550000,0xbf6d0000,0xbe480000,0x0,0xbf7b0000,0xbec40000,0x3f550000
.long 0x0,0xbf7b0000,0x3ec40000,0x3f550000,0x0,0xbf550000,0x3f6d0000,0xbe480000
.long 0x0,0xbf0e0000,0x3f6d0000,0xbf7b0000,0x0,0xbe480000,0x3ec40000,0xbf0e0000
.long 0xbf350000,0xbf550000,0xbf6d0000,0xbf7b0000,0xbf80,0xbf6d,0xbf35,0xbec4
.long 0x0,0x3f35,0x3f80,0x3f35,0x3f80,0x3ec4,0xbf35,0xbf6d
.long 0x0,0xbf80,0x0,0x3f80,0xbf80,0x3ec4,0x3f35,0xbf6d
.long 0x0,0x3f35,0xbf80,0x3f35,0x3f80,0xbf6d,0x3f35,0xbec4
.long 0x0,0x0,0x0,0x0,0xbf350000,0xbe480000,0x3ec40000,0x3f550000
.long 0x3f350000,0x3f7b0000,0x3ec40000,0xbf0e0000,0x3f350000,0xbf0e0000,0xbf6d0000,0x3e480000
.long 0xbf350000,0xbf0e0000,0x3f6d0000,0x3e480000,0xbf350000,0x3f7b0000,0xbec40000,0xbf0e0000
.long 0x3f350000,0xbe480000,0xbec40000,0x3f550000,0x3f350000,0xbf550000,0x3f6d0000,0xbf7b0000
.long 0xbf800000,0xbf7b0000,0xbf6d0000,0xbf550000,0x0,0x3ec4,0x3f35,0x3f6d
.long 0x0,0xbf35,0xbf80,0xbf35,0x0,0x3f6d,0x3f35,0xbec4
.long 0x0,0xbf80,0x0,0x3f80,0x0,0x3f6d,0xbf35,0xbec4
.long 0x0,0xbf35,0x3f80,0xbf35,0x0,0x3ec4,0xbf35,0x3f6d
.long 0x0,0x0,0x0,0x0,0x3f800000,0x3f550000,0x3ec40000,0xbe480000
.long 0xbf800000,0xbf0e0000,0x3ec40000,0x3f7b0000,0x3f800000,0x3e480000,0xbf6d0000,0xbf0e0000
.long 0xbf800000,0x3e480000,0x3f6d0000,0xbf0e0000,0x3f800000,0xbf0e0000,0xbec40000,0x3f7b0000
.long 0xbf800000,0x3f550000,0xbec40000,0xbe480000,0x3f800000,0xbf7b0000,0x3f6d0000,0xbf550000
.long 0xbf350000,0xbf0e0000,0xbec40000,0xbe480000,0x3f80,0x3f6d,0x3f35,0x3ec4
.long 0x0,0x3f35,0x3f80,0x3f35,0xbf80,0xbec4,0x3f35,0x3f6d
.long 0x0,0xbf80,0x0,0x3f80,0x3f80,0xbec4,0xbf35,0x3f6d
.long 0x0,0x3f35,0xbf80,0x3f35,0xbf80,0x3f6d,0xbf35,0x3ec4
.long 0x0,0x0,0x0,0x0,0xbf350000,0xbf7b0000,0xbf6d0000,0xbf0e0000
.long 0x3f350000,0xbe480000,0xbf6d0000,0xbf550000,0x3f350000,0x3f550000,0xbec40000,0xbf7b0000
.long 0xbf350000,0x3f550000,0x3ec40000,0xbf7b0000,0xbf350000,0xbe480000,0x3f6d0000,0xbf550000
.long 0x3f350000,0xbf7b0000,0x3f6d0000,0xbf0e0000,0x3f350000,0xbf0e0000,0x3ec40000,0xbe480000
.long 0x3f80,0x3f80,0x3f80,0x3f80,0x3f80,0x3f353f35,0x3f800000,0x3f35bf35
.long 0x3f80,0x3f800000,0xbf80,0xbf800000,0x3f80,0x3f35bf35,0xbf800000,0x3f353f35
.long 0x3f80,0xbf80,0x3f80,0xbf80,0x3f80,0xbf35bf35,0x3f800000,0xbf353f35
.long 0x3f80,0xbf800000,0xbf80,0x3f800000,0x3f80,0xbf353f35,0xbf800000,0xbf35bf35
.long 0x0,0x0,0x0,0x0,0x0,0x0,0x0,0x0
.long 0x0,0x0,0x0,0x0,0x0,0x0,0x0,0x0
.long 0x0,0x0,0x0,0x0,0x0,0x0,0x0,0x0
.long 0x0,0x0,0x0,0x0,0x0,0x0,0x0,0x0
.long 0x3f80,0x3f80,0x3f80,0x3f80,0xbf80,0xbf35bf35,0xbf800000,0xbf353f35
.long 0x3f80,0x3f800000,0xbf80,0xbf800000,0xbf80,0xbf353f35,0x3f800000,0xbf35bf35
.long 0x3f80,0xbf80,0x3f80,0xbf80,0xbf80,0x3f353f35,0xbf800000,0x3f35bf35
.long 0x3f80,0xbf800000,0xbf80,0x3f800000,0xbf80,0x3f35bf35,0x3f800000,0x3f353f35
.long 0x0,0x0,0x0,0x0,0x0,0x0,0x0,0x0
.long 0x0,0x0,0x0,0x0,0x0,0x0,0x0,0x0
.long 0x0,0x0,0x0,0x0,0x0,0x0,0x0,0x0
.long 0x0,0x0,0x0,0x0,0x0,0x0,0x0,0x0
.long 0x0,0x0,0x0,0x0,0x0,0x0,0x0,0x0
.long 0x0,0x0,0x0,0x0,0x0,0x0,0x0,0x0
.long 0x0,0x0,0x0,0x0,0x0,0x0,0x0,0x0
.long 0x0,0x0,0x0,0x0,0x0,0x0,0x0,0x0
.long 0x3f80,0x3f80,0x3f80,0x3f80,0x3f80,0x3f353f35,0x3f800000,0x3f35bf35
.long 0x3f80,0x3f800000,0xbf80,0xbf800000,0x3f80,0x3f35bf35,0xbf800000,0x3f353f35
.long 0x3f80,0xbf80,0x3f80,0xbf80,0x3f80,0xbf35bf35,0x3f800000,0xbf353f35
.long 0x3f80,0xbf800000,0xbf80,0x3f800000,0x3f80,0xbf353f35,0xbf800000,0xbf35bf35
.long 0x0,0x0,0x0,0x0,0x0,0x0,0x0,0x0
.long 0x0,0x0,0x0,0x0,0x0,0x0,0x0,0x0
.long 0x0,0x0,0x0,0x0,0x0,0x0,0x0,0x0
.long 0x0,0x0,0x0,0x0,0x0,0x0,0x0,0x0
.long 0x3f80,0x3f80,0x3f80,0x3f80,0xbf80,0xbf35bf35,0xbf800000,0xbf353f35
.long 0x3f80,0x3f800000,0xbf80,0xbf800000,0xbf80,0xbf353f35,0x3f800000,0xbf35bf35
.long 0x3f80,0xbf80,0x3f80,0xbf80,0xbf80,0x3f353f35,0xbf800000,0x3f35bf35
.long 0x3f80,0xbf800000,0xbf80,0x3f800000,0xbf80,0x3f35bf35,0x3f800000,0x3f353f35
.long 0x3f800000,0x3f800000,0x3f800000,0x3f800000,0x3f800000,0x3f35bf35,0xbf80,0xbf35bf35
.long 0x3f800000,0xbf80,0xbf800000,0x3f80,0x3f800000,0xbf35bf35,0x3f80,0x3f35bf35
.long 0x3f800000,0xbf800000,0x3f800000,0xbf800000,0x3f800000,0xbf353f35,0xbf80,0x3f353f35
.long 0x3f800000,0x3f80,0xbf800000,0xbf80,0x3f800000,0x3f353f35,0x3f80,0xbf353f35
.long 0x0,0x0,0x0,0x0,0x0,0x0,0x0,0x0
.long 0x0,0x0,0x0,0x0,0x0,0x0,0x0,0x0
.long 0x0,0x0,0x0,0x0,0x0,0x0,0x0,0x0
.long 0x0,0x0,0x0,0x0,0x0,0x0,0x0,0x0
.long 0x3f800000,0x3f800000,0x3f800000,0x3f800000,0xbf800000,0xbf353f35,0x3f80,0x3f353f35
.long 0x3f800000,0xbf80,0xbf800000,0x3f80,0xbf800000,0x3f353f35,0xbf80,0xbf353f35
.long 0x3f800000,0xbf800000,0x3f800000,0xbf800000,0xbf800000,0x3f35bf35,0x3f80,0xbf35bf35
.long 0x3f800000,0x3f80,0xbf800000,0xbf80,0xbf800000,0xbf35bf35,0xbf80,0x3f35bf35
.long 0x0,0x0,0x0,0x0,0x0,0x0,0x0,0x0
.long 0x0,0x0,0x0,0x0,0x0,0x0,0x0,0x0
.long 0x0,0x0,0x0,0x0,0x0,0x0,0x0,0x0
.long 0x0,0x0,0x0,0x0,0x0,0x0,0x0,0x0
.long 0x0,0x0,0x0,0x0,0x0,0x0,0x0,0x0
.long 0x0,0x0,0x0,0x0,0x0,0x0,0x0,0x0
.long 0x0,0x0,0x0,0x0,0x0,0x0,0x0,0x0
.long 0x0,0x0,0x0,0x0,0x0,0x0,0x0,0x0
.long 0x3f800000,0x3f800000,0x3f800000,0x3f800000,0x3f800000,0x3f35bf35,0xbf80,0xbf35bf35
.long 0x3f800000,0xbf80,0xbf800000,0x3f80,0x3f800000,0xbf35bf35,0x3f80,0x3f35bf35
.long 0x3f800000,0xbf800000,0x3f800000,0xbf800000,0x3f800000,0xbf353f35,0xbf80,0x3f353f35
.long 0x3f800000,0x3f80,0xbf800000,0xbf80,0x3f800000,0x3f353f35,0x3f80,0xbf353f35
.long 0x0,0x0,0x0,0x0,0x0,0x0,0x0,0x0
.long 0x0,0x0,0x0,0x0,0x0,0x0,0x0,0x0
.long 0x0,0x0,0x0,0x0,0x0,0x0,0x0,0x0
.long 0x0,0x0,0x0,0x0,0x0,0x0,0x0,0x0
.long 0x3f800000,0x3f800000,0x3f800000,0x3f800000,0xbf800000,0xbf353f35,0x3f80,0x3f353f35
.long 0x3f800000,0xbf80,0xbf800000,0x3f80,0xbf800000,0x3f353f35,0xbf80,0xbf353f35
.long 0x3f800000,0xbf800000,0x3f800000,0xbf800000,0xbf800000,0x3f35bf35,0x3f80,0xbf35bf35
.long 0x3f800000,0x3f80,0xbf800000,0xbf80,0xbf800000,0xbf35bf35,0xbf80,0x3f35bf35
.long 0x3f80,0x3f80,0x3f80,0x3f80,0x3f80,0x3ec43f6d,0x3f353f35,0x3f6d3ec4
.long 0x3f80,0x3f353f35,0x3f800000,0x3f35bf35,0x3f80,0x3f6d3ec4,0x3f35bf35,0xbec4bf6d
.long 0x3f80,0x3f800000,0xbf80,0xbf800000,0x3f80,0x3f6dbec4,0xbf35bf35,0xbec43f6d
.long 0x3f80,0x3f35bf35,0xbf800000,0x3f353f35,0x3f80,0x3ec4bf6d,0xbf353f35,0x3f6dbec4
.long 0x3f80,0xbf80,0x3f80,0xbf80,0x3f80,0xbec4bf6d,0x3f353f35,0xbf6dbec4
.long 0x3f80,0xbf35bf35,0x3f800000,0xbf353f35,0x3f80,0xbf6dbec4,0x3f35bf35,0x3ec43f6d
.long 0x3f80,0xbf800000,0xbf80,0x3f800000,0x3f80,0xbf6d3ec4,0xbf35bf35,0x3ec4bf6d
.long 0x3f80,0xbf353f35,0xbf800000,0xbf35bf35,0x3f80,0xbec43f6d,0xbf353f35,0xbf6d3ec4
.long 0x3f80,0x3f80,0x3f80,0x3f80,0x3f800000,0x3f6dbec4,0x3f35bf35,0x3ec4bf6d
.long 0xbf80,0xbf35bf35,0xbf800000,0xbf353f35,0xbf800000,0xbec43f6d,0x3f353f35,0x3f6dbec4
.long 0x3f80,0x3f800000,0xbf80,0xbf800000,0x3f800000,0xbec4bf6d,0xbf353f35,0x3f6d3ec4
.long 0xbf80,0xbf353f35,0x3f800000,0xbf35bf35,0xbf800000,0x3f6d3ec4,0xbf35bf35,0x3ec43f6d
.long 0x3f80,0xbf80,0x3f80,0xbf80,0x3f800000,0xbf6d3ec4,0x3f35bf35,0xbec43f6d
.long 0xbf80,0x3f353f35,0xbf800000,0x3f35bf35,0xbf800000,0x3ec4bf6d,0x3f353f35,0xbf6d3ec4
.long 0x3f80,0xbf800000,0xbf80,0x3f800000,0x3f800000,0x3ec43f6d,0xbf353f35,0xbf6dbec4
.long 0xbf80,0x3f35bf35,0x3f800000,0x3f353f35,0xbf800000,0xbf6dbec4,0xbf35bf35,0xbec4bf6d
.long 0x3f80,0x3f80,0x3f80,0x3f80,0xbf80,0xbec4bf6d,0xbf35bf35,0xbf6dbec4
.long 0x3f80,0x3f353f35,0x3f800000,0x3f35bf35,0xbf80,0xbf6dbec4,0xbf353f35,0x3ec43f6d
.long 0x3f80,0x3f800000,0xbf80,0xbf800000,0xbf80,0xbf6d3ec4,0x3f353f35,0x3ec4bf6d
.long 0x3f80,0x3f35bf35,0xbf800000,0x3f353f35,0xbf80,0xbec43f6d,0x3f35bf35,0xbf6d3ec4
.long 0x3f80,0xbf80,0x3f80,0xbf80,0xbf80,0x3ec43f6d,0xbf35bf35,0x3f6d3ec4
.long 0x3f80,0xbf35bf35,0x3f800000,0xbf353f35,0xbf80,0x3f6d3ec4,0xbf353f35,0xbec4bf6d
.long 0x3f80,0xbf800000,0xbf80,0x3f800000,0xbf80,0x3f6dbec4,0x3f353f35,0xbec43f6d
.long 0x3f80,0xbf353f35,0xbf800000,0xbf35bf35,0xbf80,0x3ec4bf6d,0x3f35bf35,0x3f6dbec4
.long 0x3f80,0x3f80,0x3f80,0x3f80,0xbf800000,0xbf6d3ec4,0xbf353f35,0xbec43f6d
.long 0xbf80,0xbf35bf35,0xbf800000,0xbf353f35,0x3f800000,0x3ec4bf6d,0xbf35bf35,0xbf6d3ec4
.long 0x3f80,0x3f800000,0xbf80,0xbf800000,0xbf800000,0x3ec43f6d,0x3f35bf35,0xbf6dbec4
.long 0xbf80,0xbf353f35,0x3f800000,0xbf35bf35,0x3f800000,0xbf6dbec4,0x3f353f35,0xbec4bf6d
.long 0x3f80,0xbf80,0x3f80,0xbf80,0xbf800000,0x3f6dbec4,0xbf353f35,0x3ec4bf6d
.long 0xbf80,0x3f353f35,0xbf800000,0x3f35bf35,0x3f800000,0xbec43f6d,0xbf35bf35,0x3f6dbec4
.long 0x3f80,0xbf800000,0xbf80,0x3f800000,0xbf800000,0xbec4bf6d,0x3f35bf35,0x3f6d3ec4
.long 0xbf80,0x3f35bf35,0x3f800000,0x3f353f35,0x3f800000,0x3f6d3ec4,0x3f353f35,0x3ec43f6d
.long 0x3f800000,0x3f800000,0x3f800000,0x3f800000,0x3f800000,0x3f6dbec4,0x3f35bf35,0x3ec4bf6d
.long 0x3f800000,0x3f35bf35,0xbf80,0xbf35bf35,0x3f800000,0x3ec4bf6d,0xbf35bf35,0xbf6d3ec4
.long 0x3f800000,0xbf80,0xbf800000,0x3f80,0x3f800000,0xbec4bf6d,0xbf353f35,0x3f6d3ec4
.long 0x3f800000,0xbf35bf35,0x3f80,0x3f35bf35,0x3f800000,0xbf6dbec4,0x3f353f35,0xbec4bf6d
.long 0x3f800000,0xbf800000,0x3f800000,0xbf800000,0x3f800000,0xbf6d3ec4,0x3f35bf35,0xbec43f6d
.long 0x3f800000,0xbf353f35,0xbf80,0x3f353f35,0x3f800000,0xbec43f6d,0xbf35bf35,0x3f6dbec4
.long 0x3f800000,0x3f80,0xbf800000,0xbf80,0x3f800000,0x3ec43f6d,0xbf353f35,0xbf6dbec4
.long 0x3f800000,0x3f353f35,0x3f80,0xbf353f35,0x3f800000,0x3f6d3ec4,0x3f353f35,0x3ec43f6d
.long 0x3f800000,0x3f800000,0x3f800000,0x3f800000,0xbf80,0xbec4bf6d,0xbf35bf35,0xbf6dbec4
.long 0xbf800000,0xbf353f35,0x3f80,0x3f353f35,0x3f80,0x3f6d3ec4,0x3f35bf35,0xbec4bf6d
.long 0x3f800000,0xbf80,0xbf800000,0x3f80,0xbf80,0xbf6d3ec4,0x3f353f35,0x3ec4bf6d
.long 0xbf800000,0x3f353f35,0xbf80,0xbf353f35,0x3f80,0x3ec4bf6d,0xbf353f35,0x3f6dbec4
.long 0x3f800000,0xbf800000,0x3f800000,0xbf800000,0xbf80,0x3ec43f6d,0xbf35bf35,0x3f6d3ec4
.long 0xbf800000,0x3f35bf35,0x3f80,0xbf35bf35,0x3f80,0xbf6dbec4,0x3f35bf35,0x3ec43f6d
.long 0x3f800000,0x3f80,0xbf800000,0xbf80,0xbf80,0x3f6dbec4,0x3f353f35,0xbec43f6d
.long 0xbf800000,0xbf35bf35,0xbf80,0x3f35bf35,0x3f80,0xbec43f6d,0xbf353f35,0xbf6d3ec4
.long 0x3f800000,0x3f800000,0x3f800000,0x3f800000,0xbf800000,0xbf6d3ec4,0xbf353f35,0xbec43f6d
.long 0x3f800000,0x3f35bf35,0xbf80,0xbf35bf35,0xbf800000,0xbec43f6d,0x3f353f35,0x3f6dbec4
.long 0x3f800000,0xbf80,0xbf800000,0x3f80,0xbf800000,0x3ec43f6d,0x3f35bf35,0xbf6dbec4
.long 0x3f800000,0xbf35bf35,0x3f80,0x3f35bf35,0xbf800000,0x3f6d3ec4,0xbf35bf35,0x3ec43f6d
.long 0x3f800000,0xbf800000,0x3f800000,0xbf800000,0xbf800000,0x3f6dbec4,0xbf353f35,0x3ec4bf6d
.long 0x3f800000,0xbf353f35,0xbf80,0x3f353f35,0xbf800000,0x3ec4bf6d,0x3f353f35,0xbf6d3ec4
.long 0x3f800000,0x3f80,0xbf800000,0xbf80,0xbf800000,0xbec4bf6d,0x3f35bf35,0x3f6d3ec4
.long 0x3f800000,0x3f353f35,0x3f80,0xbf353f35,0xbf800000,0xbf6dbec4,0xbf35bf35,0xbec4bf6d
.long 0x3f800000,0x3f800000,0x3f800000,0x3f800000,0x3f80,0x3ec43f6d,0x3f353f35,0x3f6d3ec4
.long 0xbf800000,0xbf353f35,0x3f80,0x3f353f35,0xbf80,0xbf6dbec4,0xbf353f35,0x3ec43f6d
.long 0x3f800000,0xbf80,0xbf800000,0x3f80,0x3f80,0x3f6dbec4,0xbf35bf35,0xbec43f6d
.long 0xbf800000,0x3f353f35,0xbf80,0xbf353f35,0xbf80,0xbec43f6d,0x3f35bf35,0xbf6d3ec4
.long 0x3f800000,0xbf800000,0x3f800000,0xbf800000,0x3f80,0xbec4bf6d,0x3f353f35,0xbf6dbec4
.long 0xbf800000,0x3f35bf35,0x3f80,0xbf35bf35,0xbf80,0x3f6d3ec4,0xbf353f35,0xbec4bf6d
.long 0x3f800000,0x3f80,0xbf800000,0xbf80,0x3f80,0xbf6d3ec4,0xbf35bf35,0x3ec4bf6d
.long 0xbf800000,0xbf35bf35,0xbf80,0x3f35bf35,0xbf80,0x3ec4bf6d,0x3f35bf35,0x3f6dbec4
.long 0x3f80,0x3f80,0x3f80,0x3f80,0x3f80,0xbec43f6d,0xbf353f35,0xbf6d3ec4
.long 0x3f80,0xbf353f35,0xbf800000,0xbf35bf35,0x3f80,0xbf6d3ec4,0xbf35bf35,0x3ec4bf6d
.long 0x3f80,0xbf800000,0xbf80,0x3f800000,0x3f80,0xbf6dbec4,0x3f35bf35,0x3ec43f6d
.long 0x3f80,0xbf35bf35,0x3f800000,0xbf353f35,0x3f80,0xbec4bf6d,0x3f353f35,0xbf6dbec4
.long 0x3f80,0xbf80,0x3f80,0xbf80,0x3f80,0x3ec4bf6d,0xbf353f35,0x3f6dbec4
.long 0x3f80,0x3f35bf35,0xbf800000,0x3f353f35,0x3f80,0x3f6dbec4,0xbf35bf35,0xbec43f6d
.long 0x3f80,0x3f800000,0xbf80,0xbf800000,0x3f80,0x3f6d3ec4,0x3f35bf35,0xbec4bf6d
.long 0x3f80,0x3f353f35,0x3f800000,0x3f35bf35,0x3f80,0x3ec43f6d,0x3f353f35,0x3f6d3ec4
.long 0x3f80,0x3f80,0x3f80,0x3f80,0xbf800000,0xbf6dbec4,0xbf35bf35,0xbec4bf6d
.long 0xbf80,0x3f35bf35,0x3f800000,0x3f353f35,0x3f800000,0x3ec43f6d,0xbf353f35,0xbf6dbec4
.long 0x3f80,0xbf800000,0xbf80,0x3f800000,0xbf800000,0x3ec4bf6d,0x3f353f35,0xbf6d3ec4
.long 0xbf80,0x3f353f35,0xbf800000,0x3f35bf35,0x3f800000,0xbf6d3ec4,0x3f35bf35,0xbec43f6d
.long 0x3f80,0xbf80,0x3f80,0xbf80,0xbf800000,0x3f6d3ec4,0xbf35bf35,0x3ec43f6d
.long 0xbf80,0xbf353f35,0x3f800000,0xbf35bf35,0x3f800000,0xbec4bf6d,0xbf353f35,0x3f6d3ec4
.long 0x3f80,0x3f800000,0xbf80,0xbf800000,0xbf800000,0xbec43f6d,0x3f353f35,0x3f6dbec4
.long 0xbf80,0xbf35bf35,0xbf800000,0xbf353f35,0x3f800000,0x3f6dbec4,0x3f35bf35,0x3ec4bf6d
.long 0x3f80,0x3f80,0x3f80,0x3f80,0xbf80,0xbec4bf6d,0xbf35bf35,0xbf6dbec4
.long 0x3f80,0x3f353f35,0x3f800000,0x3f35bf35,0xbf80,0xbf6dbec4,0xbf353f35,0x3ec43f6d
.long 0x3f80,0x3f800000,0xbf80,0xbf800000,0xbf80,0xbf6d3ec4,0x3f353f35,0x3ec4bf6d
.long 0x3f80,0x3f35bf35,0xbf800000,0x3f353f35,0xbf80,0xbec43f6d,0x3f35bf35,0xbf6d3ec4
.long 0x3f80,0xbf80,0x3f80,0xbf80,0xbf80,0x3ec43f6d,0xbf35bf35,0x3f6d3ec4
.long 0x3f80,0xbf35bf35,0x3f800000,0xbf353f35,0xbf80,0x3f6d3ec4,0xbf353f35,0xbec4bf6d
.long 0x3f80,0xbf800000,0xbf80,0x3f800000,0xbf80,0x3f6dbec4,0x3f353f35,0xbec43f6d
.long 0x3f80,0xbf353f35,0xbf800000,0xbf35bf35,0xbf80,0x3ec4bf6d,0x3f35bf35,0x3f6dbec4
.long 0x3f80,0x3f80,0x3f80,0x3f80,0xbf800000,0xbf6d3ec4,0xbf353f35,0xbec43f6d
.long 0xbf80,0xbf35bf35,0xbf800000,0xbf353f35,0x3f800000,0x3ec4bf6d,0xbf35bf35,0xbf6d3ec4
.long 0x3f80,0x3f800000,0xbf80,0xbf800000,0xbf800000,0x3ec43f6d,0x3f35bf35,0xbf6dbec4
.long 0xbf80,0xbf353f35,0x3f800000,0xbf35bf35,0x3f800000,0xbf6dbec4,0x3f353f35,0xbec4bf6d
.long 0x3f80,0xbf80,0x3f80,0xbf80,0xbf800000,0x3f6dbec4,0xbf353f35,0x3ec4bf6d
.long 0xbf80,0x3f353f35,0xbf800000,0x3f35bf35,0x3f800000,0xbec43f6d,0xbf35bf35,0x3f6dbec4
.long 0x3f80,0xbf800000,0xbf80,0x3f800000,0xbf800000,0xbec4bf6d,0x3f35bf35,0x3f6d3ec4
.long 0xbf80,0x3f35bf35,0x3f800000,0x3f353f35,0x3f800000,0x3f6d3ec4,0x3f353f35,0x3ec43f6d
.long 0x3f800000,0x3f800000,0x3f800000,0x3f800000,0x3f800000,0x3f6d3ec4,0x3f353f35,0x3ec43f6d
.long 0x3f800000,0x3f353f35,0x3f80,0xbf353f35,0x3f800000,0x3ec43f6d,0xbf353f35,0xbf6dbec4
.long 0x3f800000,0x3f80,0xbf800000,0xbf80,0x3f800000,0xbec43f6d,0xbf35bf35,0x3f6dbec4
.long 0x3f800000,0xbf353f35,0xbf80,0x3f353f35,0x3f800000,0xbf6d3ec4,0x3f35bf35,0xbec43f6d
.long 0x3f800000,0xbf800000,0x3f800000,0xbf800000,0x3f800000,0xbf6dbec4,0x3f353f35,0xbec4bf6d
.long 0x3f800000,0xbf35bf35,0x3f80,0x3f35bf35,0x3f800000,0xbec4bf6d,0xbf353f35,0x3f6d3ec4
.long 0x3f800000,0xbf80,0xbf800000,0x3f80,0x3f800000,0x3ec4bf6d,0xbf35bf35,0xbf6d3ec4
.long 0x3f800000,0x3f35bf35,0xbf80,0xbf35bf35,0x3f800000,0x3f6dbec4,0x3f35bf35,0x3ec4bf6d
.long 0x3f800000,0x3f800000,0x3f800000,0x3f800000,0x3f80,0xbec43f6d,0xbf353f35,0xbf6d3ec4
.long 0xbf800000,0xbf35bf35,0xbf80,0x3f35bf35,0xbf80,0x3f6dbec4,0x3f353f35,0xbec43f6d
.long 0x3f800000,0x3f80,0xbf800000,0xbf80,0x3f80,0xbf6dbec4,0x3f35bf35,0x3ec43f6d
.long 0xbf800000,0x3f35bf35,0x3f80,0xbf35bf35,0xbf80,0x3ec43f6d,0xbf35bf35,0x3f6d3ec4
.long 0x3f800000,0xbf800000,0x3f800000,0xbf800000,0x3f80,0x3ec4bf6d,0xbf353f35,0x3f6dbec4
.long 0xbf800000,0x3f353f35,0xbf80,0xbf353f35,0xbf80,0xbf6d3ec4,0x3f353f35,0x3ec4bf6d
.long 0x3f800000,0xbf80,0xbf800000,0x3f80,0x3f80,0x3f6d3ec4,0x3f35bf35,0xbec4bf6d
.long 0xbf800000,0xbf353f35,0x3f80,0x3f353f35,0xbf80,0xbec4bf6d,0xbf35bf35,0xbf6dbec4
.long 0xbf800000,0xbf800000,0xbf800000,0xbf800000,0x3f800000,0x3f6dbec4,0x3f35bf35,0x3ec4bf6d
.long 0xbf800000,0xbf353f35,0x3f80,0x3f353f35,0x3f800000,0x3ec4bf6d,0xbf35bf35,0xbf6d3ec4
.long 0xbf800000,0x3f80,0x3f800000,0xbf80,0x3f800000,0xbec4bf6d,0xbf353f35,0x3f6d3ec4
.long 0xbf800000,0x3f353f35,0xbf80,0xbf353f35,0x3f800000,0xbf6dbec4,0x3f353f35,0xbec4bf6d
.long 0xbf800000,0x3f800000,0xbf800000,0x3f800000,0x3f800000,0xbf6d3ec4,0x3f35bf35,0xbec43f6d
.long 0xbf800000,0x3f35bf35,0x3f80,0xbf35bf35,0x3f800000,0xbec43f6d,0xbf35bf35,0x3f6dbec4
.long 0xbf800000,0xbf80,0x3f800000,0x3f80,0x3f800000,0x3ec43f6d,0xbf353f35,0xbf6dbec4
.long 0xbf800000,0xbf35bf35,0xbf80,0x3f35bf35,0x3f800000,0x3f6d3ec4,0x3f353f35,0x3ec43f6d
.long 0xbf800000,0xbf800000,0xbf800000,0xbf800000,0xbf80,0xbec4bf6d,0xbf35bf35,0xbf6dbec4
.long 0x3f800000,0x3f35bf35,0xbf80,0xbf35bf35,0x3f80,0x3f6d3ec4,0x3f35bf35,0xbec4bf6d
.long 0xbf800000,0x3f80,0x3f800000,0xbf80,0xbf80,0xbf6d3ec4,0x3f353f35,0x3ec4bf6d
.long 0x3f800000,0xbf35bf35,0x3f80,0x3f35bf35,0x3f80,0x3ec4bf6d,0xbf353f35,0x3f6dbec4
.long 0xbf800000,0x3f800000,0xbf800000,0x3f800000,0xbf80,0x3ec43f6d,0xbf35bf35,0x3f6d3ec4
.long 0x3f800000,0xbf353f35,0xbf80,0x3f353f35,0x3f80,0xbf6dbec4,0x3f35bf35,0x3ec43f6d
.long 0xbf800000,0xbf80,0x3f800000,0x3f80,0xbf80,0x3f6dbec4,0x3f353f35,0xbec43f6d
.long 0x3f800000,0x3f353f35,0x3f80,0xbf353f35,0x3f80,0xbec43f6d,0xbf353f35,0xbf6d3ec4
.long 0x0,0x4000,0x4000,0x4000,0x0,0xbf443fed,0xbfb53fb5,0xbfed3f44
.long 0x0,0xbfb53fb5,0xc0000000,0xbfb5bfb5,0x0,0xbfed3f44,0xbfb5bfb5,0x3f44bfed
.long 0x0,0xc0000000,0xc000,0x40000000,0x0,0xbfedbf44,0x3fb5bfb5,0x3f443fed
.long 0x0,0xbfb5bfb5,0x40000000,0xbfb53fb5,0x0,0xbf44bfed,0x3fb53fb5,0xbfedbf44
.long 0x0,0xc000,0x4000,0xc000,0x0,0x3f44bfed,0xbfb53fb5,0x3fedbf44
.long 0x0,0x3fb5bfb5,0xc0000000,0x3fb53fb5,0x0,0x3fedbf44,0xbfb5bfb5,0xbf443fed
.long 0x0,0x40000000,0xc000,0xc0000000,0x0,0x3fed3f44,0x3fb5bfb5,0xbf44bfed
.long 0x0,0x3fb53fb5,0x40000000,0x3fb5bfb5,0x0,0x3f443fed,0x3fb53fb5,0x3fed3f44
.long 0x4000,0x4000,0x4000,0x4000,0xc0000000,0xbfedbf44,0xbfb5bfb5,0xbf44bfed
.long 0xc000,0x3fb5bfb5,0x40000000,0x3fb53fb5,0x40000000,0x3f443fed,0xbfb53fb5,0xbfedbf44
.long 0x4000,0xc0000000,0xc000,0x40000000,0xc0000000,0x3f44bfed,0x3fb53fb5,0xbfed3f44
.long 0xc000,0x3fb53fb5,0xc0000000,0x3fb5bfb5,0x40000000,0xbfed3f44,0x3fb5bfb5,0xbf443fed
.long 0x4000,0xc000,0x4000,0xc000,0xc0000000,0x3fed3f44,0xbfb5bfb5,0x3f443fed
.long 0xc000,0xbfb53fb5,0x40000000,0xbfb5bfb5,0x40000000,0xbf44bfed,0xbfb53fb5,0x3fed3f44
.long 0x4000,0x40000000,0xc000,0xc0000000,0xc0000000,0xbf443fed,0x3fb53fb5,0x3fedbf44
.long 0xc000,0xbfb5bfb5,0xc0000000,0xbfb53fb5,0x40000000,0x3fedbf44,0x3fb5bfb5,0x3f44bfed
.long 0x3f80,0x0,0x0,0x0,0xbf80,0x0,0x0,0x0
.long 0x3f80,0x0,0x0,0x0,0xbf80,0x0,0x0,0x0
.long 0x3f80,0x0,0x0,0x0,0xbf80,0x0,0x0,0x0
.long 0x3f80,0x0,0x0,0x0,0xbf80,0x0,0x0,0x0
.long 0x3f80,0x0,0x0,0x0,0xbf80,0x0,0x0,0x0
.long 0x3f80,0x0,0x0,0x0,0xbf80,0x0,0x0,0x0
.long 0x3f80,0x0,0x0,0x0,0xbf80,0x0,0x0,0x0
.long 0x3f80,0x0,0x0,0x0,0xbf80,0x0,0x0,0x0
.long 0x0,0x0,0x0,0x0,0x0,0x0,0x0,0x0
.long 0x0,0x0,0x0,0x0,0x0,0x0,0x0,0x0
.long 0x0,0x0,0x0,0x0,0x0,0x0,0x0,0x0
.long 0x0,0x0,0x0,0x0,0x0,0x0,0x0,0x0
.long 0x0,0x0,0x0,0x0,0x0,0x0,0x0,0x0
.long 0x0,0x0,0x0,0x0,0x0,0x0,0x0,0x0
.long 0x0,0x0,0x0,0x0,0x0,0x0,0x0,0x0
.long 0x0,0x0,0x0,0x0,0x0,0x0,0x0,0x0
.long 0x4000,0x0,0x0,0x0,0xbec83ffb,0x0,0x0,0x0
.long 0xbf443fed,0x0,0x0,0x0,0xbf8e3fd5,0x0,0x0,0x0
.long 0xbfb53fb5,0x0,0x0,0x0,0xbfd53f8e,0x0,0x0,0x0
.long 0xbfed3f44,0x0,0x0,0x0,0xbffb3ec8,0x0,0x0,0x0
.long 0xc0000000,0x0,0x0,0x0,0xbffbbec8,0x0,0x0,0x0
.long 0xbfedbf44,0x0,0x0,0x0,0xbfd5bf8e,0x0,0x0,0x0
.long 0xbfb5bfb5,0x0,0x0,0x0,0xbf8ebfd5,0x0,0x0,0x0
.long 0xbf44bfed,0x0,0x0,0x0,0xbec8bffb,0x0,0x0,0x0
.long 0x0,0x0,0x0,0x0,0x0,0x0,0x0,0x0
.long 0x0,0x0,0x0,0x0,0x0,0x0,0x0,0x0
.long 0x0,0x0,0x0,0x0,0x0,0x0,0x0,0x0
.long 0x0,0x0,0x0,0x0,0x0,0x0,0x0,0x0
.long 0x0,0x0,0x0,0x0,0x0,0x0,0x0,0x0
.long 0x0,0x0,0x0,0x0,0x0,0x0,0x0,0x0
.long 0x0,0x0,0x0,0x0,0x0,0x0,0x0,0x0
.long 0x0,0x0,0x0,0x0,0x0,0x0,0x0,0x0
.long 0x0,0x4000,0x4000,0x4000,0x0,0xbf8e3fd5,0xbfd53f8e,0xbffb3ec8
.long 0x0,0xbfed3f44,0xbfedbf44,0xbf44bfed,0x0,0xbffbbec8,0xbec8bffb,0x3fd5bf8e
.long 0x0,0xbfb5bfb5,0x3fb5bfb5,0x3fb53fb5,0x0,0xbec8bffb,0x3ffb3ec8,0xbf8e3fd5
.long 0x0,0x3f44bfed,0x3f443fed,0xbfedbf44,0x0,0x3fd5bf8e,0xbf8e3fd5,0x3ec8bffb
.long 0x0,0x40000000,0xc0000000,0x40000000,0x0,0x3fd53f8e,0xbf8ebfd5,0x3ec83ffb
.long 0x0,0x3f443fed,0x3f44bfed,0xbfed3f44,0x0,0xbec83ffb,0x3ffbbec8,0xbf8ebfd5
.long 0x0,0xbfb53fb5,0x3fb53fb5,0x3fb5bfb5,0x0,0xbffb3ec8,0xbec83ffb,0x3fd53f8e
.long 0x0,0xbfedbf44,0xbfed3f44,0xbf443fed,0x0,0xbf8ebfd5,0xbfd5bf8e,0xbffbbec8
.long 0x4000,0x4000,0x4000,0x4000,0xbffbbec8,0xbfd5bf8e,0xbf8ebfd5,0xbec8bffb
.long 0x3f44bfed,0x3fedbf44,0x3fed3f44,0x3f443fed,0x3fd53f8e,0xbec83ffb,0xbffb3ec8,0xbf8ebfd5
.long 0xbfb53fb5,0xbfb5bfb5,0x3fb5bfb5,0x3fb53fb5,0xbf8ebfd5,0x3ffbbec8,0xbec83ffb,0xbfd5bf8e
.long 0x3fedbf44,0xbf443fed,0xbf44bfed,0x3fed3f44,0x3ec83ffb,0xbf8ebfd5,0x3fd53f8e,0xbffbbec8
.long 0xc0000000,0x40000000,0xc0000000,0x40000000,0x3ec8bffb,0xbf8e3fd5,0x3fd5bf8e,0xbffb3ec8
.long 0x3fed3f44,0xbf44bfed,0xbf443fed,0x3fedbf44,0xbf8e3fd5,0x3ffb3ec8,0xbec8bffb,0xbfd53f8e
.long 0xbfb5bfb5,0xbfb53fb5,0x3fb53fb5,0x3fb5bfb5,0x3fd5bf8e,0xbec8bffb,0xbffbbec8,0xbf8e3fd5
.long 0x3f443fed,0x3fed3f44,0x3fedbf44,0x3f44bfed,0xbffb3ec8,0xbfd53f8e,0xbf8e3fd5,0xbec83ffb
.long 0x35803580,0x3600,0x3600,0x3600,0xb5803580,0xb4c835fb,0xb54435ed,0xb58e35d5
.long 0x35803580,0xb54435ed,0xb5b535b5,0xb5ed3544,0xb5803580,0xb58e35d5,0xb5ed3544,0xb5fbb4c8
.long 0x35803580,0xb5b535b5,0xb6000000,0xb5b5b5b5,0xb5803580,0xb5d5358e,0xb5edb544,0xb4c8b5fb
.long 0x35803580,0xb5ed3544,0xb5b5b5b5,0x3544b5ed,0xb5803580,0xb5fb34c8,0xb544b5ed,0x35d5b58e
.long 0x35803580,0xb6000000,0xb600,0x36000000,0xb5803580,0xb5fbb4c8,0x3544b5ed,0x35d5358e
.long 0x35803580,0xb5edb544,0x35b5b5b5,0x354435ed,0xb5803580,0xb5d5b58e,0x35edb544,0xb4c835fb
.long 0x35803580,0xb5b5b5b5,0x36000000,0xb5b535b5,0xb5803580,0xb58eb5d5,0x35ed3544,0xb5fb34c8
.long 0x35803580,0xb544b5ed,0x35b535b5,0xb5edb544,0xb5803580,0xb4c8b5fb,0x354435ed,0xb58eb5d5
.long 0x3600,0x3600,0x3600,0x3600,0xb5b535b5,0xb5d5358e,0xb5ed3544,0xb5fb34c8
.long 0xb6000000,0xb5edb544,0xb5b5b5b5,0xb544b5ed,0xb5b5b5b5,0xb4c8b5fb,0x3544b5ed,0x35d5b58e
.long 0xb600,0x35b5b5b5,0x36000000,0x35b535b5,0x35b5b5b5,0x35fb34c8,0x354435ed,0xb58e35d5
.long 0x36000000,0x354435ed,0xb5b535b5,0xb5edb544,0x35b535b5,0xb58e35d5,0xb5edb544,0x34c8b5fb
.long 0x3600,0xb6000000,0xb600,0x36000000,0xb5b535b5,0xb58eb5d5,0x35edb544,0x34c835fb
.long 0xb6000000,0x3544b5ed,0x35b535b5,0xb5ed3544,0xb5b5b5b5,0x35fbb4c8,0xb54435ed,0xb58eb5d5
.long 0xb600,0x35b535b5,0xb6000000,0x35b5b5b5,0x35b5b5b5,0xb4c835fb,0xb544b5ed,0x35d5358e
.long 0x36000000,0xb5ed3544,0x35b5b5b5,0xb54435ed,0x35b535b5,0xb5d5b58e,0x35ed3544,0xb5fbb4c8
.long 0x3600,0x3600,0x3600,0x3600,0xb6000000,0xb5fbb4c8,0xb5edb544,0xb5d5b58e
.long 0xb600,0x3544b5ed,0x35b5b5b5,0x35edb544,0x36000000,0x35d5358e,0x354435ed,0xb4c835fb
.long 0x3600,0xb5b535b5,0xb6000000,0xb5b5b5b5,0xb6000000,0xb58eb5d5,0x3544b5ed,0x35fbb4c8
.long 0xb600,0x35edb544,0x35b535b5,0xb54435ed,0x36000000,0x34c835fb,0xb5ed3544,0xb58eb5d5
.long 0x3600,0xb6000000,0xb600,0x36000000,0xb6000000,0x34c8b5fb,0x35ed3544,0xb58e35d5
.long 0xb600,0x35ed3544,0xb5b535b5,0xb544b5ed,0x36000000,0xb58e35d5,0xb544b5ed,0x35fb34c8
.long 0x3600,0xb5b5b5b5,0x36000000,0xb5b535b5,0xb6000000,0x35d5b58e,0xb54435ed,0xb4c8b5fb
.long 0xb600,0x354435ed,0xb5b5b5b5,0x35ed3544,0x36000000,0xb5fb34c8,0x35edb544,0xb5d5358e
.long 0x3600,0x3600,0x3600,0x3600,0xb5b5b5b5,0xb58eb5d5,0xb544b5ed,0xb4c8b5fb
.long 0x36000000,0x35ed3544,0x35b535b5,0x354435ed,0xb5b535b5,0xb5fb34c8,0xb5edb544,0xb58eb5d5
.long 0xb600,0x35b5b5b5,0x36000000,0x35b535b5,0x35b535b5,0xb4c835fb,0xb5ed3544,0xb5d5b58e
.long 0xb6000000,0xb544b5ed,0x35b5b5b5,0x35ed3544,0x35b5b5b5,0x35d5358e,0xb54435ed,0xb5fbb4c8
.long 0x3600,0xb6000000,0xb600,0x36000000,0xb5b5b5b5,0x35d5b58e,0x354435ed,0xb5fb34c8
.long 0x36000000,0xb54435ed,0xb5b5b5b5,0x35edb544,0xb5b535b5,0xb4c8b5fb,0x35ed3544,0xb5d5358e
.long 0xb600,0x35b535b5,0xb6000000,0x35b5b5b5,0x35b535b5,0xb5fbb4c8,0x35edb544,0xb58e35d5
.long 0xb6000000,0x35edb544,0xb5b535b5,0x3544b5ed,0x35b5b5b5,0xb58e35d5,0x3544b5ed,0xb4c835fb
.long 0x35803580,0xb600,0x3600,0xb600,0xb5803580,0x34c8b5fb,0xb54435ed,0x358eb5d5
.long 0x35803580,0x3544b5ed,0xb5b535b5,0x35edb544,0xb5803580,0x358eb5d5,0xb5ed3544,0x35fb34c8
.long 0x35803580,0x35b5b5b5,0xb6000000,0x35b535b5,0xb5803580,0x35d5b58e,0xb5edb544,0x34c835fb
.long 0x35803580,0x35edb544,0xb5b5b5b5,0xb54435ed,0xb5803580,0x35fbb4c8,0xb544b5ed,0xb5d5358e
.long 0x35803580,0x36000000,0xb600,0xb6000000,0xb5803580,0x35fb34c8,0x3544b5ed,0xb5d5b58e
.long 0x35803580,0x35ed3544,0x35b5b5b5,0xb544b5ed,0xb5803580,0x35d5358e,0x35edb544,0x34c8b5fb
.long 0x35803580,0x35b535b5,0x36000000,0x35b5b5b5,0xb5803580,0x358e35d5,0x35ed3544,0x35fbb4c8
.long 0x35803580,0x354435ed,0x35b535b5,0x35ed3544,0xb5803580,0x34c835fb,0x354435ed,0x358e35d5
.long 0x3600,0xb600,0x3600,0xb600,0xb5b535b5,0x35d5b58e,0xb5ed3544,0x35fbb4c8
.long 0xb6000000,0x35ed3544,0xb5b5b5b5,0x354435ed,0xb5b5b5b5,0x34c835fb,0x3544b5ed,0xb5d5358e
.long 0xb600,0xb5b535b5,0x36000000,0xb5b5b5b5,0x35b5b5b5,0xb5fbb4c8,0x354435ed,0x358eb5d5
.long 0x36000000,0xb544b5ed,0xb5b535b5,0x35ed3544,0x35b535b5,0x358eb5d5,0xb5edb544,0xb4c835fb
.long 0x3600,0x36000000,0xb600,0xb6000000,0xb5b535b5,0x358e35d5,0x35edb544,0xb4c8b5fb
.long 0xb6000000,0xb54435ed,0x35b535b5,0x35edb544,0xb5b5b5b5,0xb5fb34c8,0xb54435ed,0x358e35d5
.long 0xb600,0xb5b5b5b5,0xb6000000,0xb5b535b5,0x35b5b5b5,0x34c8b5fb,0xb544b5ed,0xb5d5b58e
.long 0x36000000,0x35edb544,0x35b5b5b5,0x3544b5ed,0x35b535b5,0x35d5358e,0x35ed3544,0x35fb34c8
.long 0x3600,0xb600,0x3600,0xb600,0xb6000000,0x35fb34c8,0xb5edb544,0x35d5358e
.long 0xb600,0xb54435ed,0x35b5b5b5,0xb5ed3544,0x36000000,0xb5d5b58e,0x354435ed,0x34c8b5fb
.long 0x3600,0x35b5b5b5,0xb6000000,0x35b535b5,0xb6000000,0x358e35d5,0x3544b5ed,0xb5fb34c8
.long 0xb600,0xb5ed3544,0x35b535b5,0x3544b5ed,0x36000000,0xb4c8b5fb,0xb5ed3544,0x358e35d5
.long 0x3600,0x36000000,0xb600,0xb6000000,0xb6000000,0xb4c835fb,0x35ed3544,0x358eb5d5
.long 0xb600,0xb5edb544,0xb5b535b5,0x354435ed,0x36000000,0x358eb5d5,0xb544b5ed,0xb5fbb4c8
.long 0x3600,0x35b535b5,0x36000000,0x35b5b5b5,0xb6000000,0xb5d5358e,0xb54435ed,0x34c835fb
.long 0xb600,0xb544b5ed,0xb5b5b5b5,0xb5edb544,0x36000000,0x35fbb4c8,0x35edb544,0x35d5b58e
.long 0x3600,0xb600,0x3600,0xb600,0xb5b5b5b5,0x358e35d5,0xb544b5ed,0x34c835fb
.long 0x36000000,0xb5edb544,0x35b535b5,0xb544b5ed,0xb5b535b5,0x35fbb4c8,0xb5edb544,0x358e35d5
.long 0xb600,0xb5b535b5,0x36000000,0xb5b5b5b5,0x35b535b5,0x34c8b5fb,0xb5ed3544,0x35d5358e
.long 0xb6000000,0x354435ed,0x35b5b5b5,0xb5edb544,0x35b5b5b5,0xb5d5b58e,0xb54435ed,0x35fb34c8
.long 0x3600,0x36000000,0xb600,0xb6000000,0xb5b5b5b5,0xb5d5358e,0x354435ed,0x35fbb4c8
.long 0x36000000,0x3544b5ed,0xb5b5b5b5,0xb5ed3544,0xb5b535b5,0x34c835fb,0x35ed3544,0x35d5b58e
.long 0xb600,0xb5b5b5b5,0xb6000000,0xb5b535b5,0x35b535b5,0x35fb34c8,0x35edb544,0x358eb5d5
.long 0xb6000000,0xb5ed3544,0xb5b535b5,0xb54435ed,0x35b5b5b5,0x358eb5d5,0x3544b5ed,0x34c8b5fb
.long 0x3f800000,0x3f800000,0x3f800000,0x3f800000,0x3f800000,0x3f7ffb11,0x3f7fec43,0x3f7fd397
.long 0x3f800000,0x3f7fec43,0x3f7fb10f,0x3f7f4e6d,0x3f800000,0x3f7fd397,0x3f7f4e6d,0x3f7e70b0
.long 0x3f800000,0x3f7fb10f,0x3f7ec46d,0x3f7d3aac,0x3f800000,0x3f7f84ab,0x3f7e1324,0x3f7baccd
.long 0x3f800000,0x3f7f4e6d,0x3f7d3aac,0x3f79c79d,0x3f800000,0x3f7f0e58,0x3f7c3b28,0x3f778bc5
.long 0x3f800000,0x3f7ec46d,0x3f7b14be,0x3f74fa0b,0x3f800000,0x3f7e70b0,0x3f79c79d,0x3f721352
.long 0x3f800000,0x3f7e1324,0x3f7853f8,0x3f6ed89e,0x3f800000,0x3f7dabcc,0x3f76ba07,0x3f6b4b0c
.long 0x3f800000,0x3f7d3aac,0x3f74fa0b,0x3f676bd8,0x3f800000,0x3f7cbfc9,0x3f731447,0x3f633c5a
.long 0x3f800000,0x3f7c3b28,0x3f710908,0x3f5ebe05,0x3f800000,0x3f7baccd,0x3f6ed89e,0x3f59f26a
.long 0x3f800000,0x3f800000,0x3f800000,0x3f800000,0x3f7fb10f,0x3f7f84ab,0x3f7f4e6d,0x3f7f0e58
.long 0x3f7ec46d,0x3f7e1324,0x3f7d3aac,0x3f7c3b28,0x3f7d3aac,0x3f7baccd,0x3f79c79d,0x3f778bc5
.long 0x3f7b14be,0x3f7853f8,0x3f74fa0b,0x3f710908,0x3f7853f8,0x3f740bdd,0x3f6ed89e,0x3f68bf3c
.long 0x3f74fa0b,0x3f6ed89e,0x3f676bd8,0x3f5ebe05,0x3f710908,0x3f68bf3c,0x3f5ebe05,0x3f531849
.long 0x3f6c835e,0x3f61c598,0x3f54db31,0x3f45e403,0x3f676bd8,0x3f59f26a,0x3f49d112,0x3f373a23
.long 0x3f61c598,0x3f514d3d,0x3f3daef9,0x3f273656,0x3f5b941a,0x3f47de65,0x3f3085bb,0x3f15f6d9
.long 0x3f54db31,0x3f3daef9,0x3f226799,0x3f039c3d,0x3f4d9f02,0x3f32c8c9,0x3f13682a,0x3ee0924f
.long 0x3f45e403,0x3f273656,0x3f039c3d,0x3eb8442a,0x3f3daef9,0x3f1b02c6,0x3ee63375,0x3e8e9a22
.long 0x3f800000,0x3f800000,0x3f800000,0x3f800000,0x3f7ec46d,0x3f7e70b0,0x3f7e1324,0x3f7dabcc
.long 0x3f7b14be,0x3f79c79d,0x3f7853f8,0x3f76ba07,0x3f74fa0b,0x3f721352,0x3f6ed89e,0x3f6b4b0c
.long 0x3f6c835e,0x3f676bd8,0x3f61c598,0x3f5b941a,0x3f61c598,0x3f59f26a,0x3f514d3d,0x3f47de65
.long 0x3f54db31,0x3f49d112,0x3f3daef9,0x3f3085bb,0x3f45e403,0x3f373a23,0x3f273656,0x3f15f6d9
.long 0x3f3504f3,0x3f226799,0x3f0e39da,0x3ef15aea,0x3f226799,0x3f0b9a6b,0x3ee63375,0x3eb263ef
.long 0x3f0e39da,0x3ee63375,0x3eac7cd4,0x3e605c13,0x3ef15aea,0x3eb263ef,0x3e605c13,0x3dafb680
.long 0x3ec3ef15,0x3e78cfcc,0x3dc8bd36,0xbd48fb30,0x3e94a031,0x3e09cf86,0xbcc90ab0,0xbe3b6ecf
.long 0x3e47c5c2,0x3cc90ab0,0xbe164083,0xbea09ae5,0x3dc8bd36,0xbdafb680,0xbe888e93,0xbee0924f
.long 0x3f800000,0x3f800000,0x3f800000,0x3f800000,0x3f7d3aac,0x3f7cbfc9,0x3f7c3b28,0x3f7baccd
.long 0x3f74fa0b,0x3f731447,0x3f710908,0x3f6ed89e,0x3f676bd8,0x3f633c5a,0x3f5ebe05,0x3f59f26a
.long 0x3f54db31,0x3f4d9f02,0x3f45e403,0x3f3daef9,0x3f3daef9,0x3f32c8c9,0x3f273656,0x3f1b02c6
.long 0x3f226799,0x3f13682a,0x3f039c3d,0x3ee63375,0x3f039c3d,0x3ee0924f,0x3eb8442a,0x3e8e9a22
.long 0x3ec3ef15,0x3e94a031,0x3e47c5c2,0x3dc8bd36,0x3e78cfcc,0x3e09cf86,0x3cc90ab0,0xbdafb680
.long 0x3dc8bd36,0xbcc90ab0,0xbe164083,0xbe888e93,0xbd48fb30,0xbe3b6ecf,0xbea09ae5,0xbee0924f
.long 0xbe47c5c2,0xbeac7cd4,0xbef15aea,0xbf187fc0,0xbeac7cd4,0xbef6e0cb,0xbf1d7fd1,0xbf3b8f3b
.long 0xbef15aea,0xbf1d7fd1,0xbf3daef9,0xbf584853,0xbf187fc0,0xbf3b8f3b,0xbf584853,0xbf6db293
.long 0x0,0x0,0x0,0x0,0x0,0x3c490e90,0x3cc90ab0,0x3d16c32c
.long 0x0,0x3cc90ab0,0x3d48fb30,0x3d96a905,0x0,0x3d16c32c,0x3d96a905,0x3de1bc2e
.long 0x0,0x3d48fb30,0x3dc8bd36,0x3e164083,0x0,0x3d7b2b74,0x3dfab273,0x3e3b6ecf
.long 0x0,0x3d96a905,0x3e164083,0x3e605c13,0x0,0x3dafb680,0x3e2f10a2,0x3e827dc0
.long 0x0,0x3dc8bd36,0x3e47c5c2,0x3e94a031,0x0,0x3de1bc2e,0x3e605c13,0x3ea68f12
.long 0x0,0x3dfab273,0x3e78cfcc,0x3eb8442a,0x0,0x3e09cf86,0x3e888e93,0x3ec9b953
.long 0x0,0x3e164083,0x3e94a031,0x3edae880,0x0,0x3e22abb6,0x3ea09ae5,0x3eebcbbb
.long 0x0,0x3e2f10a2,0x3eac7cd4,0x3efc5d27,0x0,0x3e3b6ecf,0x3eb8442a,0x3f064b82
.long 0x0,0x0,0x0,0x0,0x3d48fb30,0x3d7b2b74,0x3d96a905,0x3dafb680
.long 0x3dc8bd36,0x3dfab273,0x3e164083,0x3e2f10a2,0x3e164083,0x3e3b6ecf,0x3e605c13,0x3e827dc0
.long 0x3e47c5c2,0x3e78cfcc,0x3e94a031,0x3eac7cd4,0x3e78cfcc,0x3e9aa086,0x3eb8442a,0x3ed53641
.long 0x3e94a031,0x3eb8442a,0x3edae880,0x3efc5d27,0x3eac7cd4,0x3ed53641,0x3efc5d27,0x3f10d3cd
.long 0x3ec3ef15,0x3ef15aea,0x3f0e39da,0x3f226799,0x3edae880,0x3f064b82,0x3f1d7fd1,0x3f32c8c9
.long 0x3ef15aea,0x3f13682a,0x3f2beb4a,0x3f41d870,0x3f039c3d,0x3f1ff6cb,0x3f396842,0x3f4f7a1f
.long 0x3f0e39da,0x3f2beb4a,0x3f45e403,0x3f5b941a,0x3f187fc0,0x3f373a23,0x3f514d3d,0x3f660f88
.long 0x3f226799,0x3f41d870,0x3f5b941a,0x3f6ed89e,0x3f2beb4a,0x3f4bbbf8,0x3f64aa59,0x3f75dec6
.long 0x0,0x0,0x0,0x0,0x3dc8bd36,0x3de1bc2e,0x3dfab273,0x3e09cf86
.long 0x3e47c5c2,0x3e605c13,0x3e78cfcc,0x3e888e93,0x3e94a031,0x3ea68f12,0x3eb8442a,0x3ec9b953
.long 0x3ec3ef15,0x3edae880,0x3ef15aea,0x3f039c3d,0x3ef15aea,0x3f064b82,0x3f13682a,0x3f1ff6cb
.long 0x3f0e39da,0x3f1d7fd1,0x3f2beb4a,0x3f396842,0x3f226799,0x3f32c8c9,0x3f41d870,0x3f4f7a1f
.long 0x3f3504f3,0x3f45e403,0x3f54db31,0x3f61c598,0x3f45e403,0x3f5695e5,0x3f64aa59,0x3f6ff573
.long 0x3f54db31,0x3f64aa59,0x3f710908,0x3f79c79d,0x3f61c598,0x3f6ff573,0x3f79c79d,0x3f7f0e58
.long 0x3f6c835e,0x3f7853f8,0x3f7ec46d,0x3f7fb10f,0x3f74fa0b,0x3f7dabcc,0x3f7fec43,0x3f7baccd
.long 0x3f7b14be,0x3f7fec43,0x3f7d3aac,0x3f731447,0x3f7ec46d,0x3f7f0e58,0x3f76ba07,0x3f660f88
.long 0x0,0x0,0x0,0x0,0x3e164083,0x3e22abb6,0x3e2f10a2,0x3e3b6ecf
.long 0x3e94a031,0x3ea09ae5,0x3eac7cd4,0x3eb8442a,0x3edae880,0x3eebcbbb,0x3efc5d27,0x3f064b82
.long 0x3f0e39da,0x3f187fc0,0x3f226799,0x3f2beb4a,0x3f2beb4a,0x3f373a23,0x3f41d870,0x3f4bbbf8
.long 0x3f45e403,0x3f514d3d,0x3f5b941a,0x3f64aa59,0x3f5b941a,0x3f660f88,0x3f6ed89e,0x3f75dec6
.long 0x3f6c835e,0x3f74fa0b,0x3f7b14be,0x3f7ec46d,0x3f7853f8,0x3f7dabcc,0x3f7fec43,0x3f7f0e58
.long 0x3f7ec46d,0x3f7fec43,0x3f7d3aac,0x3f76ba07,0x3f7fb10f,0x3f7baccd,0x3f731447,0x3f660f88
.long 0x3f7b14be,0x3f710908,0x3f61c598,0x3f4d9f02,0x3f710908,0x3f604621,0x3f49d112,0x3f2e3bde
.long 0x3f61c598,0x3f49d112,0x3f2beb4a,0x3f08f59b,0x3f4d9f02,0x3f2e3bde,0x3f08f59b,0x3ebe1d4a
.long 0x0,0x0,0x3f803f80,0x3f803f80,0x0,0x0,0x3f800000,0x3f803f80
.long 0x0,0x0,0x0,0x3f803f80,0x0,0x0,0x0,0x3f800000
.long 0x0,0x0,0x0,0x0,0x0,0x0,0x0,0x0
.long 0x0,0x0,0x0,0x0,0x0,0x0,0x0,0x0
.long 0x0,0x0,0x0,0x0,0x0,0x0,0x0,0x0
.long 0x0,0x0,0x0,0x0,0x0,0x0,0x0,0x0
.long 0x0,0x0,0x0,0x0,0x0,0x0,0x0,0x0
.long 0x0,0x0,0x0,0x0,0x0,0x0,0x0,0x0
.long 0x3f803f80,0x3f803f80,0x3f80,0x0,0x3f803f80,0x3f803f80,0x3f803f80,0x0
.long 0x3f803f80,0x3f803f80,0x3f803f80,0x3f80,0x3f803f80,0x3f803f80,0x3f803f80,0x3f803f80
.long 0x3f803f80,0x3f803f80,0x3f803f80,0x3f803f80,0x3f800000,0x3f803f80,0x3f803f80,0x3f803f80
.long 0x0,0x3f803f80,0x3f803f80,0x3f803f80,0x0,0x3f800000,0x3f803f80,0x3f803f80
.long 0x0,0x0,0x3f803f80,0x3f803f80,0x0,0x0,0x3f800000,0x3f803f80
.long 0x0,0x0,0x0,0x3f803f80,0x0,0x0,0x0,0x3f800000
.long 0x0,0x0,0x0,0x0,0x0,0x0,0x0,0x0
.long 0x0,0x0,0x0,0x0,0x0,0x0,0x0,0x0
.long 0x0,0x0,0x0,0x0,0x0,0x0,0x0,0x0
.long 0x0,0x0,0x0,0x0,0x0,0x0,0x0,0x0
.long 0x3f80,0x0,0x0,0x0,0x3f803f80,0x0,0x0,0x0
.long 0x3f803f80,0x3f80,0x0,0x0,0x3f803f80,0x3f803f80,0x0,0x0
.long 0x3f803f80,0x3f803f80,0x3f80,0x0,0x3f803f80,0x3f803f80,0x3f803f80,0x0
.long 0x3f803f80,0x3f803f80,0x3f803f80,0x3f80,0x3f803f80,0x3f803f80,0x3f803f80,0x3f803f80
.long 0x3f803f80,0x3f803f80,0x3f803f80,0x3f803f80,0x3f800000,0x3f803f80,0x3f803f80,0x3f803f80
.long 0x0,0x3f803f80,0x3f803f80,0x3f803f80,0x0,0x3f800000,0x3f803f80,0x3f803f80
.long 0x0,0x0,0x0,0x0,0x0,0x0,0x0,0x0
.long 0x0,0x0,0x0,0x0,0x0,0x0,0x0,0x0
.long 0x0,0x0,0x0,0x0,0x0,0x0,0x0,0x0
.long 0x0,0x0,0x0,0x0,0x0,0x0,0x0,0x0
.long 0x0,0x0,0x0,0x0,0x0,0x0,0x0,0x0
.long 0x0,0x0,0x0,0x0,0x0,0x0,0x0,0x0
.long 0x3f80,0x0,0x0,0x0,0x3f803f80,0x0,0x0,0x0
.long 0x3f803f80,0x3f80,0x0,0x0,0x3f803f80,0x3f803f80,0x0,0x0
.long 0x0,0x0,0x3f800000,0x3f803f80,0x0,0x0,0x0,0x3f803f80
.long 0x0,0x0,0x0,0x3f800000,0x0,0x0,0x0,0x0
.long 0x0,0x0,0x0,0x0,0x0,0x0,0x0,0x0
.long 0x0,0x0,0x0,0x0,0x0,0x0,0x0,0x0
.long 0x0,0x0,0x0,0x0,0x0,0x0,0x0,0x0
.long 0x0,0x0,0x0,0x0,0x0,0x0,0x0,0x0
.long 0x0,0x0,0x0,0x0,0x0,0x0,0x0,0x0
.long 0x0,0x0,0x0,0x0,0x0,0x0,0x0,0x0
.long 0x3f803f80,0x3f803f80,0x0,0x0,0x3f803f80,0x3f803f80,0x3f80,0x0
.long 0x3f803f80,0x3f803f80,0x3f803f80,0x0,0x3f803f80,0x3f803f80,0x3f803f80,0x3f80
.long 0x3f800000,0x3f803f80,0x3f803f80,0x3f803f80,0x0,0x3f803f80,0x3f803f80,0x3f803f80
.long 0x0,0x3f800000,0x3f803f80,0x3f803f80,0x0,0x0,0x3f803f80,0x3f803f80
.long 0x0,0x0,0x3f800000,0x3f803f80,0x0,0x0,0x0,0x3f803f80
.long 0x0,0x0,0x0,0x3f800000,0x0,0x0,0x0,0x0
.long 0x0,0x0,0x0,0x0,0x0,0x0,0x0,0x0
.long 0x0,0x0,0x0,0x0,0x0,0x0,0x0,0x0
.long 0x0,0x0,0x0,0x0,0x0,0x0,0x0,0x0
.long 0x0,0x0,0x0,0x0,0x0,0x0,0x0,0x0
.long 0x0,0x0,0x0,0x0,0x3f80,0x0,0x0,0x0
.long 0x3f803f80,0x0,0x0,0x0,0x3f803f80,0x3f80,0x0,0x0
.long 0x3f803f80,0x3f803f80,0x0,0x0,0x3f803f80,0x3f803f80,0x3f80,0x0
.long 0x3f803f80,0x3f803f80,0x3f803f80,0x0,0x3f803f80,0x3f803f80,0x3f803f80,0x3f80
.long 0x3f800000,0x3f803f80,0x3f803f80,0x3f803f80,0x0,0x3f803f80,0x3f803f80,0x3f803f80
.long 0x0,0x3f800000,0x3f803f80,0x3f803f80,0x0,0x0,0x3f803f80,0x3f803f80
.long 0x0,0x0,0x0,0x0,0x0,0x0,0x0,0x0
.long 0x0,0x0,0x0,0x0,0x0,0x0,0x0,0x0
.long 0x0,0x0,0x0,0x0,0x0,0x0,0x0,0x0
.long 0x0,0x0,0x0,0x0,0x0,0x0,0x0,0x0
.long 0x0,0x0,0x0,0x0,0x0,0x0,0x0,0x0
.long 0x0,0x0,0x0,0x0,0x0,0x0,0x0,0x0
.long 0x0,0x0,0x0,0x0,0x3f80,0x0,0x0,0x0
.long 0x3f803f80,0x0,0x0,0x0,0x3f803f80,0x3f80,0x0,0x0
.long 0xa400a40,0xa400a40,0xa400a40,0xa400a40,0xa400a40,0xa000a40,0xa000a00,0xa000a00
.long 0xa000a00,0x9f809f8,0x9f409f8,0x9f409f4,0x9f409f4,0x9ec09ec,0x9e809ec,0x9e809e8
.long 0x9e809e8,0x9e009e0,0x9dc09e0,0x9dc09dc,0x9dc09dc,0x9d409d4,0x9d009d4,0x9d009d0
.long 0x9d009d0,0x9c809c8,0x9c409c8,0x9c409c4,0x9c409c4,0x9bc09bc,0x9b809bc,0x9b809b8
.long 0x9b809b8,0x9b009b0,0x9ac09b0,0x9ac09ac,0x9ac09ac,0x9a409a4,0x9a009a4,0x9a009a0
.long 0x9a009a0,0x9980998,0x9940998,0x9940994,0x9940994,0x98c098c,0x988098c,0x9880988
.long 0x9880988,0x9800980,0x97c0980,0x97c097c,0x97c097c,0x9740974,0x9700974,0x9700970
.long 0x9700970,0x9680968,0x9640968,0x9640964,0x9640964,0x95c095c,0x958095c,0x9580958
.long 0x9580958,0x9500950,0x94c0950,0x94c094c,0x94c094c,0x9440944,0x9400944,0x9400940
.long 0x9400940,0x9380938,0x9340938,0x9340934,0x9340934,0x92c092c,0x928092c,0x9280928
.long 0x9280928,0x9200920,0x91c0920,0x91c091c,0x91c091c,0x9140914,0x9100914,0x9100910
.long 0x9100910,0x9080908,0x9040908,0x9040904,0x9040904,0x8fc08fc,0x8f808fc,0x8f808f8
.long 0x8f808f8,0x8f008f0,0x8ec08f0,0x8ec08ec,0x8ec08ec,0x8e408e4,0x8e008e4,0x8e008e0
.long 0x8e008e0,0x8d808d8,0x8d408d8,0x8d408d4,0x8d408d4,0x8cc08cc,0x8c808cc,0x8c808c8
.long 0x8c808c8,0x8c008c0,0x8bc08c0,0x8bc08bc,0x8bc08bc,0x8b408b4,0x8b008b4,0x8b008b0
.long 0x8b008b0,0x8a808a8,0x8a408a8,0x8a408a4,0x8a408a4,0x89c089c,0x898089c,0x8980898
.long 0x8980898,0x8900890,0x88c0890,0x88c088c,0x88c088c,0x8840884,0x8800884,0x8800880
.long 0x8800880,0x8780878,0x8740878,0x8740874,0x8740874,0x86c086c,0x868086c,0x8680868
.long 0x8680868,0x8600860,0x85c0860,0x85c085c,0x85c085c,0x8540854,0x8500854,0x8500850
.long 0x8500850,0x8480848,0x8440848,0x8440844,0x8440844,0x83c083c,0x838083c,0x8380838
.long 0x8380838,0x8300830,0x82c0830,0x82c082c,0x82c082c,0x8240824,0x8200824,0x8200820
.long 0x8200820,0x8180818,0x8140818,0x8140814,0x8140814,0x80c080c,0x808080c,0x8080808
.long 0x8080808,0x8000800,0x7fc0800,0x7fc07fc,0x7fc07fc,0x7f407f4,0x7f007f4,0x7f007f0
.long 0x7f007f0,0x7e807e8,0x7e407e8,0x7e407e4,0x7e407e4,0x7dc07dc,0x7d807dc,0x7d807d8
.long 0x7d807d8,0x7d007d0,0x7cc07d0,0x7cc07cc,0x7cc07cc,0x7c407c4,0x7c007c4,0x7c007c0
.long 0x7c007c0,0x7b807b8,0x7b407b8,0x7b407b4,0x7b407b4,0x7ac07ac,0x7a807ac,0x7a807a8
.long 0x7a807a8,0x7a007a0,0x79c07a0,0x79c079c,0x79c079c,0x7940794,0x7900794,0x7900790
.long 0x7900790,0x7880788,0x7840788,0x7840784,0x7840784,0x77c077c,0x778077c,0x7780778
.long 0x7780778,0x7700770,0x76c0770,0x76c076c,0x76c076c,0x7640764,0x7600764,0x7600760
.long 0x7600760,0x7580758,0x7540758,0x7540754,0x7540754,0x74c074c,0x748074c,0x7480748
.long 0x7480748,0x7400740,0x73c0740,0x73c073c,0x73c073c,0x7340734,0x7300734,0x7300730
.long 0x7300730,0x7280728,0x7240728,0x7240724,0x7240724,0x71c071c,0x718071c,0x7180718
.long 0x7180718,0x7100710,0x70c0710,0x70c070c,0x70c070c,0x7040704,0x7000704,0x7000700
.long 0x6f80700,0x6f406f4,0x6f006f4,0x6ec06ec,0x6e406ec,0x6e006e0,0x6dc06e0,0x6d806d8
.long 0x6d006d8,0x6cc06cc,0x6c806cc,0x6c406c4,0x6bc06c4,0x6b806b8,0x6b406b8,0x6b006b0
.long 0x6a806b0,0x6a406a4,0x6a006a4,0x69c069c,0x694069c,0x6900690,0x68c0690,0x6880688
.long 0x6800688,0x67c067c,0x678067c,0x6740674,0x66c0674,0x6680668,0x6640668,0x6600660
.long 0x6580660,0x6540654,0x6500654,0x64c064c,0x644064c,0x6400640,0x63c0640,0x6380638
.long 0x6300638,0x62c062c,0x628062c,0x6240624,0x61c0624,0x6180618,0x6140618,0x6100610
.long 0x6080610,0x6040604,0x6000604,0x5fc05fc,0x5f405fc,0x5f005f0,0x5ec05f0,0x5e805e8
.long 0x5e005e8,0x5dc05dc,0x5d805dc,0x5d405d4,0x5cc05d4,0x5c805c8,0x5c405c8,0x5c005c0
.long 0x5b805c0,0x5b405b4,0x5b005b4,0x5ac05ac,0x5a405ac,0x5a005a0,0x59c05a0,0x5980598
.long 0x5900598,0x58c058c,0x588058c,0x5840584,0x57c0584,0x5780578,0x5740578,0x5700570
.long 0x5680570,0x5640564,0x5600564,0x55c055c,0x554055c,0x5500550,0x54c0550,0x5480548
.long 0x5400548,0x53c053c,0x538053c,0x5340534,0x52c0534,0x5280528,0x5240528,0x5200520
.long 0x5180520,0x5140514,0x5100514,0x50c050c,0x504050c,0x5000500,0x4fc0500,0x4f804f8
.long 0x4f004f8,0x4ec04ec,0x4e804ec,0x4e404e4,0x4dc04e4,0x4d804d8,0x4d404d8,0x4d004d0
.long 0x4c804d0,0x4c404c4,0x4c004c4,0x4bc04bc,0x4b404bc,0x4b004b0,0x4ac04b0,0x4a804a8
.long 0x4a004a8,0x49c049c,0x498049c,0x4940494,0x48c0494,0x4880488,0x4840488,0x4800480
.long 0x4740478,0x46c0470,0x4640468,0x45c0460,0x4500454,0x448044c,0x4400444,0x438043c
.long 0x42c0430,0x4240428,0x41c0420,0x4140418,0x408040c,0x4000404,0x3f803fc,0x3f003f4
.long 0x3e403e8,0x3dc03e0,0x3d403d8,0x3cc03d0,0x3c003c4,0x3b803bc,0x3b003b4,0x3a803ac
.long 0x39c03a0,0x3940398,0x38c0390,0x3840388,0x378037c,0x3700374,0x368036c,0x3600364
.long 0x3540358,0x34c0350,0x3440348,0x33c0340,0x3300334,0x328032c,0x3200324,0x318031c
.long 0x30c0310,0x3040308,0x2fc0300,0x2f402f8,0x2e802ec,0x2e002e4,0x2d802dc,0x2d002d4
.long 0x2c402c8,0x2bc02c0,0x2b402b8,0x2ac02b0,0x2a002a4,0x298029c,0x2900294,0x288028c
.long 0x27c0280,0x2740278,0x26c0270,0x2640268,0x258025c,0x2500254,0x248024c,0x2400244
.long 0x2340238,0x22c0230,0x2240228,0x21c0220,0x2100214,0x208020c,0x2000204,0x1f801fc
.long 0x1ec01f0,0x1e401e8,0x1dc01e0,0x1d401d8,0x1c801cc,0x1c001c4,0x1b801bc,0x1b001b4
.long 0x1a401a8,0x19c01a0,0x1940198,0x18c0190,0x1800184,0x178017c,0x1700174,0x168016c
.long 0x15c0160,0x1540158,0x14c0150,0x1440148,0x138013c,0x1300134,0x128012c,0x1200124
.long 0x1140118,0x10c0110,0x1040108,0xfc0100,0xf000f4,0xe800ec,0xe000e4,0xd800dc
.long 0xcc00d0,0xc400c8,0xbc00c0,0xb400b8,0xa800ac,0xa000a4,0x98009c,0x900094
.long 0x840088,0x7c0080,0x740078,0x6c0070,0x600064,0x58005c,0x500054,0x48004c
.long 0x3c0040,0x340038,0x2c0030,0x240028,0x18001c,0x100014,0x8000c,0x4
.long 0xa400a40,0xa400a40,0xa400a40,0xa400a40,0xa400a40,0xa400a40,0xa400a40,0xa400a40
.long 0x80,0x100,0x180,0x200,0x280,0x300,0x380,0x400
.long 0x480,0x500,0x580,0x600,0x680,0x700,0x780,0x0
.long 0x1fe0,0x1f60,0x1ee0,0x1e60,0x1de0,0x1d60,0x1ce0,0x1c60
.long 0x1be0,0x1b60,0x1ae0,0x1a60,0x19e0,0x1960,0x18e0,0x20
.long 0xa0,0x120,0x1a0,0x220,0x2a0,0x320,0x3a0,0x420
.long 0x4a0,0x520,0x5a0,0x620,0x6a0,0x720,0x7a0,0x1020
.long 0x1fc0,0x1f40,0x1ec0,0x1e40,0x1dc0,0x1d40,0x1cc0,0x1c40
.long 0x1bc0,0x1b40,0x1ac0,0x1a40,0x19c0,0x1940,0x18c0,0x40
.long 0xc0,0x140,0x1c0,0x240,0x2c0,0x340,0x3c0,0x440
.long 0x4c0,0x540,0x5c0,0x640,0x6c0,0x740,0x7c0,0x1040
.long 0x1fa0,0x1f20,0x1ea0,0x1e20,0x1da0,0x1d20,0x1ca0,0x1c20
.long 0x1ba0,0x1b20,0x1aa0,0x1a20,0x19a0,0x1920,0x18a0,0x60
.long 0xe0,0x160,0x1e0,0x260,0x2e0,0x360,0x3e0,0x460
.long 0x4e0,0x560,0x5e0,0x660,0x6e0,0x760,0x7e0,0x1060
.long 0x1f80,0x1f00,0x1e80,0x1e00,0x1d80,0x1d00,0x1c80,0x1c00
.long 0x1b80,0x1b00,0x1a80,0x1a00,0x1980,0x1900,0x1880,0x800
.long 0x880,0x900,0x980,0xa00,0xa80,0xb00,0xb80,0xc00
.long 0xc80,0xd00,0xd80,0xe00,0xe80,0xf00,0xf80,0x1800
.long 0x17e0,0x1760,0x16e0,0x1660,0x15e0,0x1560,0x14e0,0x1460
.long 0x13e0,0x1360,0x12e0,0x1260,0x11e0,0x1160,0x10e0,0x820
.long 0x8a0,0x920,0x9a0,0xa20,0xaa0,0xb20,0xba0,0xc20
.long 0xca0,0xd20,0xda0,0xe20,0xea0,0xf20,0xfa0,0x1820
.long 0x17c0,0x1740,0x16c0,0x1640,0x15c0,0x1540,0x14c0,0x1440
.long 0x13c0,0x1340,0x12c0,0x1240,0x11c0,0x1140,0x10c0,0x840
.long 0x8c0,0x940,0x9c0,0xa40,0xac0,0xb40,0xbc0,0xc40
.long 0xcc0,0xd40,0xdc0,0xe40,0xec0,0xf40,0xfc0,0x1840
.long 0x17a0,0x1720,0x16a0,0x1620,0x15a0,0x1520,0x14a0,0x1420
.long 0x13a0,0x1320,0x12a0,0x1220,0x11a0,0x1120,0x10a0,0x860
.long 0x8e0,0x960,0x9e0,0xa60,0xae0,0xb60,0xbe0,0xc60
.long 0xce0,0xd60,0xde0,0xe60,0xee0,0xf60,0xfe0,0x1860
.long 0x1780,0x1700,0x1680,0x1600,0x1580,0x1500,0x1480,0x1400
.long 0x1380,0x1300,0x1280,0x1200,0x1180,0x1100,0x1080,0x1000
.long 0x0,0x4,0x8,0xc,0x24,0x28,0x2c,0x30
.long 0x48,0x4c,0x50,0x54,0x6c,0x70,0x74,0x78
.long 0x90,0x94,0x98,0x9c,0xb4,0xb8,0xbc,0xc0
.long 0xd8,0xdc,0xe0,0xe4,0xfc,0x100,0x104,0x108
.long 0x120,0x124,0x128,0x12c,0x144,0x148,0x14c,0x150
.long 0x168,0x16c,0x170,0x174,0x18c,0x190,0x194,0x198
.long 0x1b0,0x1b4,0x1b8,0x1bc,0x1d4,0x1d8,0x1dc,0x1e0
.long 0x1f8,0x1fc,0x200,0x204,0x21c,0x220,0x224,0x228
.long 0x10,0x14,0x18,0x1c,0x34,0x38,0x3c,0x40
.long 0x58,0x5c,0x60,0x64,0x7c,0x80,0x84,0x88
.long 0xa0,0xa4,0xa8,0xac,0xc4,0xc8,0xcc,0xd0
.long 0xe8,0xec,0xf0,0xf4,0x10c,0x110,0x114,0x118
.long 0x130,0x134,0x138,0x13c,0x154,0x158,0x15c,0x160
.long 0x178,0x17c,0x180,0x184,0x19c,0x1a0,0x1a4,0x1a8
.long 0x1c0,0x1c4,0x1c8,0x1cc,0x1e4,0x1e8,0x1ec,0x1f0
.long 0x208,0x20c,0x210,0x214,0x22c,0x230,0x234,0x238
.long 0x240,0x244,0x248,0x24c,0x264,0x268,0x26c,0x270
.long 0x288,0x28c,0x290,0x294,0x2ac,0x2b0,0x2b4,0x2b8
.long 0x2d0,0x2d4,0x2d8,0x2dc,0x2f4,0x2f8,0x2fc,0x300
.long 0x318,0x31c,0x320,0x324,0x33c,0x340,0x344,0x348
.long 0x360,0x364,0x368,0x36c,0x384,0x388,0x38c,0x390
.long 0x3a8,0x3ac,0x3b0,0x3b4,0x3cc,0x3d0,0x3d4,0x3d8
.long 0x3f0,0x3f4,0x3f8,0x3fc,0x414,0x418,0x41c,0x420
.long 0x438,0x43c,0x440,0x444,0x45c,0x460,0x464,0x468
.long 0x250,0x254,0x258,0x25c,0x274,0x278,0x27c,0x280
.long 0x298,0x29c,0x2a0,0x2a4,0x2bc,0x2c0,0x2c4,0x2c8
.long 0x2e0,0x2e4,0x2e8,0x2ec,0x304,0x308,0x30c,0x310
.long 0x328,0x32c,0x330,0x334,0x34c,0x350,0x354,0x358
.long 0x370,0x374,0x378,0x37c,0x394,0x398,0x39c,0x3a0
.long 0x3b8,0x3bc,0x3c0,0x3c4,0x3dc,0x3e0,0x3e4,0x3e8
.long 0x400,0x404,0x408,0x40c,0x424,0x428,0x42c,0x430
.long 0x448,0x44c,0x450,0x454,0x46c,0x470,0x474,0x478
.long 0x480,0x484,0x488,0x48c,0x494,0x498,0x49c,0x4a0
.long 0x4a8,0x4ac,0x4b0,0x4b4,0x4bc,0x4c0,0x4c4,0x4c8
.long 0x4d0,0x4d4,0x4d8,0x4dc,0x4e4,0x4e8,0x4ec,0x4f0
.long 0x4f8,0x4fc,0x500,0x504,0x50c,0x510,0x514,0x518
.long 0x520,0x524,0x528,0x52c,0x534,0x538,0x53c,0x540
.long 0x548,0x54c,0x550,0x554,0x55c,0x560,0x564,0x568
.long 0x570,0x574,0x578,0x57c,0x584,0x588,0x58c,0x590
.long 0x598,0x59c,0x5a0,0x5a4,0x5ac,0x5b0,0x5b4,0x5b8
.long 0x5c0,0x5c4,0x5c8,0x5cc,0x5d4,0x5d8,0x5dc,0x5e0
.long 0x5e8,0x5ec,0x5f0,0x5f4,0x5fc,0x600,0x604,0x608
.long 0x610,0x614,0x618,0x61c,0x624,0x628,0x62c,0x630
.long 0x638,0x63c,0x640,0x644,0x64c,0x650,0x654,0x658
.long 0x660,0x664,0x668,0x66c,0x674,0x678,0x67c,0x680
.long 0x688,0x68c,0x690,0x694,0x69c,0x6a0,0x6a4,0x6a8
.long 0x6b0,0x6b4,0x6b8,0x6bc,0x6c4,0x6c8,0x6cc,0x6d0
.long 0x6d8,0x6dc,0x6e0,0x6e4,0x6ec,0x6f0,0x6f4,0x6f8
.long 0x700,0x704,0x7c0,0x7c4,0x70c,0x710,0x7cc,0x7d0
.long 0x718,0x71c,0x7d8,0x7dc,0x724,0x728,0x7e4,0x7e8
.long 0x730,0x734,0x7f0,0x7f4,0x73c,0x740,0x7fc,0x800
.long 0x748,0x74c,0x808,0x80c,0x754,0x758,0x814,0x818
.long 0x760,0x764,0x820,0x824,0x76c,0x770,0x82c,0x830
.long 0x778,0x77c,0x838,0x83c,0x784,0x788,0x844,0x848
.long 0x790,0x794,0x850,0x854,0x79c,0x7a0,0x85c,0x860
.long 0x7a8,0x7ac,0x868,0x86c,0x7b4,0x7b8,0x874,0x878
.long 0x880,0x884,0x940,0x944,0x88c,0x890,0x94c,0x950
.long 0x898,0x89c,0x958,0x95c,0x8a4,0x8a8,0x964,0x968
.long 0x8b0,0x8b4,0x970,0x974,0x8bc,0x8c0,0x97c,0x980
.long 0x8c8,0x8cc,0x988,0x98c,0x8d4,0x8d8,0x994,0x998
.long 0x8e0,0x8e4,0x9a0,0x9a4,0x8ec,0x8f0,0x9ac,0x9b0
.long 0x8f8,0x8fc,0x9b8,0x9bc,0x904,0x908,0x9c4,0x9c8
.long 0x910,0x914,0x9d0,0x9d4,0x91c,0x920,0x9dc,0x9e0
.long 0x928,0x92c,0x9e8,0x9ec,0x934,0x938,0x9f4,0x9f8
.long 0xa00,0xa44,0xa44,0xa44,0xa44,0xa44,0xa44,0xa44
.long 0xa44,0xa44,0xa44,0xa44,0xa44,0xa44,0xa44,0xa44
.long 0xa44,0xa44,0xa44,0xa44,0xa44,0xa44,0xa44,0xa44
.long 0xa44,0xa44,0xa44,0xa44,0xa44,0xa44,0xa44,0xa44
.long 0xa44,0xa44,0xa44,0xa44,0xa44,0xa44,0xa44,0xa44
.long 0xa44,0xa44,0xa44,0xa44,0xa44,0xa44,0xa44,0xa44
.long 0xa44,0xa44,0xa44,0xa44,0xa44,0xa44,0xa44,0xa44
.long 0xa44,0xa44,0xa44,0xa44,0xa44,0xa44,0xa44,0xa44
.long 0xa44,0xa44,0xa44,0xa44,0xa44,0xa44,0xa44,0xa44
.long 0xa44,0xa44,0xa44,0xa44,0xa44,0xa44,0xa44,0xa44
.long 0xa44,0xa44,0xa44,0xa44,0xa44,0xa44,0xa44,0xa44
.long 0xa44,0xa44,0xa44,0xa44,0xa44,0xa44,0xa44,0xa44
.long 0xa44,0xa44,0xa44,0xa44,0xa44,0xa44,0xa44,0xa44
.long 0xa44,0xa44,0xa44,0xa44,0xa44,0xa44,0xa44,0xa44
.long 0xa44,0xa44,0xa44,0xa44,0xa44,0xa44,0xa44,0xa44
.long 0xa44,0xa44,0xa44,0xa44,0xa44,0xa44,0xa44,0xa44
.long 0xa44,0xa44,0xa44,0xa44,0xa44,0xa44,0xa44,0xa44
.long 0xa44,0xa44,0xa44,0xa44,0xa44,0xa44,0xa44,0xa44
.long 0xa44,0xa44,0xa44,0xa44,0xa44,0xa44,0xa44,0xa44
.long 0xa44,0xa44,0xa44,0xa44,0xa44,0xa44,0xa44,0xa44
.long 0xa44,0xa44,0xa44,0xa44,0xa44,0xa44,0xa44,0xa44
.long 0xa44,0xa44,0xa44,0xa44,0xa44,0xa44,0xa44,0xa44
.long 0xa44,0xa44,0xa44,0xa44,0xa44,0xa44,0xa44,0xa44
.long 0xa44,0xa44,0xa44,0xa44,0xa44,0xa44,0xa44,0xa44
.long 0xa44,0xa44,0xa44,0xa44,0xa44,0xa44,0xa44,0xa44
.long 0xa44,0xa44,0xa44,0xa44,0xa44,0xa44,0xa44,0xa44
.long 0xa44,0xa44,0xa44,0xa44,0xa44,0xa44,0xa44,0xa44
.long 0xa44,0xa44,0xa44,0xa44,0xa44,0xa44,0xa44,0xa44
.long 0xa44,0xa44,0xa44,0xa44,0xa44,0xa44,0xa44,0xa44
.long 0xa44,0xa44,0xa44,0xa44,0xa44,0xa44,0xa44,0xa44
.long 0xa44,0xa44,0xa44,0xa44,0xa44,0xa44,0xa44,0xa44
.long 0xa44,0xa44,0xa44,0xa44,0xa44,0xa44,0xa44,0xa44
.long 0x11900,0x1169c,0x116bc,0x116dc,0x11800,0x11820,0x11840,0x11860
.long 0x11680,0x116a0,0x116c0,0x116e0,0x11804,0x11824,0x11844,0x11864
.long 0x11684,0x116a4,0x116c4,0x116e4,0x11808,0x11828,0x11848,0x11868
.long 0x11688,0x116a8,0x116c8,0x116e8,0x1180c,0x1182c,0x1184c,0x1186c
.long 0x1168c,0x116ac,0x116cc,0x116ec,0x11810,0x11830,0x11850,0x11870
.long 0x11690,0x116b0,0x116d0,0x116f0,0x11814,0x11834,0x11854,0x11874
.long 0x11694,0x116b4,0x116d4,0x116f4,0x11818,0x11838,0x11858,0x11878
.long 0x11698,0x116b8,0x116d8,0x116f8,0x1181c,0x1183c,0x1185c,0x1187c
.long 0x116fc,0x1171c,0x1173c,0x1175c,0x11880,0x118a0,0x118c0,0x118e0
.long 0x11700,0x11720,0x11740,0x11760,0x11884,0x118a4,0x118c4,0x118e4
.long 0x11704,0x11724,0x11744,0x11764,0x11888,0x118a8,0x118c8,0x118e8
.long 0x11708,0x11728,0x11748,0x11768,0x1188c,0x118ac,0x118cc,0x118ec
.long 0x1170c,0x1172c,0x1174c,0x1176c,0x11890,0x118b0,0x118d0,0x118f0
.long 0x11710,0x11730,0x11750,0x11770,0x11894,0x118b4,0x118d4,0x118f4
.long 0x11714,0x11734,0x11754,0x11774,0x11898,0x118b8,0x118d8,0x118f8
.long 0x11718,0x11738,0x11758,0x11778,0x1189c,0x118bc,0x118dc,0x118fc
.long 0x1177c,0x11900,0x11900,0x11900,0x11900,0x11900,0x11900,0x11900
.long 0x11900,0x11900,0x11900,0x11900,0x11900,0x11900,0x11900,0x11900
.long 0x11900,0x11900,0x11900,0x11900,0x11900,0x11900,0x11900,0x11900
.long 0x11900,0x11900,0x11900,0x11900,0x11900,0x11900,0x11900,0x11900
.long 0x11900,0x11900,0x11900,0x11900,0x11900,0x11900,0x11900,0x11900
.long 0x11900,0x11900,0x11900,0x11900,0x11900,0x11900,0x11900,0x11900
.long 0x11900,0x11900,0x11900,0x11900,0x11900,0x11900,0x11900,0x11900
.long 0x11900,0x11900,0x11900,0x11900,0x11900,0x11900,0x11900,0x11900
.long 0x11900,0x11900,0x11900,0x11900,0x11900,0x11900,0x11900,0x11900
.long 0x11900,0x11900,0x11900,0x11900,0x11900,0x11900,0x11900,0x11900
.long 0x11900,0x11900,0x11900,0x11900,0x11900,0x11900,0x11900,0x11900
.long 0x11900,0x11900,0x11900,0x11900,0x11900,0x11900,0x11900,0x11900
.long 0x11900,0x11900,0x11900,0x11900,0x11900,0x11900,0x11900,0x11900
.long 0x11900,0x11900,0x11900,0x11900,0x11900,0x11900,0x11900,0x11900
.long 0x11900,0x11900,0x11900,0x11900,0x11900,0x11900,0x11900,0x11900
.long 0x11900,0x11900,0x11900,0x11900,0x11900,0x11900,0x11900,0x11900
L_table_end:
.section .rodata,"a"
.p2align 6
.amdhsa_kernel interleave_layers__ssm_conv_s4d__spectral_gfnet__prompt_kernel
  .amdhsa_next_free_vgpr 256
  .amdhsa_next_free_sgpr 102
  .amdhsa_accum_offset 160
  .amdhsa_group_segment_fixed_size 0
  .amdhsa_kernarg_size 104
  .amdhsa_user_sgpr_count 2
  .amdhsa_user_sgpr_kernarg_segment_ptr 1
  .amdhsa_system_sgpr_workgroup_id_x 1
.end_amdhsa_kernel
```
